```python
import torch

def _softmax(x, axis=-1):
    return torch.softmax(x, dim=axis)
def _gelu(x):
    return torch.nn.functional.gelu(x, approximate="tanh")
def _silu(x):
    return torch.nn.functional.silu(x)
def _sigmoid(x):
    return torch.sigmoid(x)
def _layernorm(x, axis=-1, eps=1e-5):
    m = x.mean(dim=axis, keepdim=True)
    v = x.var(dim=axis, keepdim=True, unbiased=False)
    return (x - m) / torch.sqrt(v + eps)
def _scatter_add(tgt, idx, src, axis=0):
    return tgt.clone().index_add_(axis, idx, src)
def _segment_sum(src, seg, n):
    out = torch.zeros((n,) + src.shape[1:], dtype=src.dtype)
    return out.index_add_(0, seg, src)
def _pad(x, pw):
    flat = tuple(v for pair in reversed(pw) for v in pair)
    return torch.nn.functional.pad(x, flat)

kernel_name = 'gated_mix__linear_attn_block__glu_gated_bilinear__prompt'

def setup_inputs():

    _w = (lambda a: (lambda t: t.to(torch.bfloat16) if t.is_floating_point() else t)(torch.as_tensor(a)))
    def _A_setup():
        B, S, D = 1, 2048, 512
        return {
            "x": _w((lambda *s: torch.randn(*s, dtype=torch.bfloat16) * 0.05)(B, S, D)),
            "wqkv": _w((lambda *s: torch.randn(*s, dtype=torch.bfloat16) * 0.8)(D, 3 * D)),
            "wo": _w((lambda *s: torch.randn(*s, dtype=torch.bfloat16) * 0.05)(D, D)),
        }
    _A_in = _A_setup()

    def _B_setup():
        B, S, D, F = 1, 2048, 512, 1792
        return {
            "x": _w((lambda *s: torch.randn(*s, dtype=torch.bfloat16) * 0.05)(B, S, D)),
            "w_gate": _w((lambda *s: torch.randn(*s, dtype=torch.bfloat16) * 1.6)(D, F) * (D ** -0.5)),
            "w_up": _w((lambda *s: torch.randn(*s, dtype=torch.bfloat16) * 1.6)(D, F) * (D ** -0.5)),
            "w_down": _w((lambda *s: torch.randn(*s, dtype=torch.bfloat16) * 1.6)(F, D) * (F ** -0.5)),
        }
    _B_in = _B_setup()

    return {
        "A_x": _A_in["x"],
        "A_wqkv": _A_in["wqkv"],
        "A_wo": _A_in["wo"],
        "B_x": _B_in["x"],
        "B_w_gate": _B_in["w_gate"],
        "B_w_up": _B_in["w_up"],
        "B_w_down": _B_in["w_down"],
        "gate_w": _w((lambda *s: torch.randn(*s, dtype=torch.bfloat16) * 0.05)(512) * 16.0),
    }

def reference(A_x, A_wqkv, A_wo, B_x, B_w_gate, B_w_up, B_w_down, gate_w):
    def _A_ref(x, wqkv, wo):
        B, S, D = x.shape
        H = 32; Dh = D // H
        qkv = (lambda x, *d: x.permute(*d))((x @ wqkv).reshape(B, S, 3, H, Dh), 2, 0, 3, 1, 4)
        q, k, v = qkv[0], qkv[1], qkv[2]
        phi = lambda t: torch.where(t > 0, t + 1, torch.exp(t)) + 1e-6
        pq, pk = phi(q), phi(k)
        kv = torch.einsum("bhsd,bhse->bhde", pk, v)
        z = torch.einsum("bhsd->bhd", pk)
        num = torch.einsum("bhqd,bhde->bhqe", pq, kv)
        den = torch.einsum("bhqd,bhd->bhq", pq, z)[..., None] + 1e-6
        o = num / den
        return (lambda x, *d: x.permute(*d))(o, 0, 2, 1, 3).reshape(B, S, D) @ wo

    def _B_ref(x, w_gate, w_up, w_down):
        g = torch.einsum("bsd,df->bsf", x, w_gate)
        u = torch.einsum("bsd,df->bsf", x, w_up)
        h = g * u
        return torch.einsum("bsf,fd->bsd", h, w_down)

    x = A_x
    g = _sigmoid((x * gate_w).sum(-1, keepdims=True))
    a = _A_ref(x, A_wqkv, A_wo)
    b = _B_ref(x, B_w_gate, B_w_up, B_w_down)
    return g * a + (1 - g) * b
```

```asm
; @launch grid=(256,1,1) block=(512,1,1) lds=163840
.amdgcn_target "amdgcn-amd-amdhsa--gfx950"
.text
.globl gated_mix__linear_attn_block__glu_gated_bilinear__prompt_kernel
.p2align 12
.type gated_mix__linear_attn_block__glu_gated_bilinear__prompt_kernel,@function
gated_mix__linear_attn_block__glu_gated_bilinear__prompt_kernel:
    s_cmp_ge_u32 s2, 256
    s_cbranch_scc1 k_end
    s_load_dwordx16 s[4:19], s[0:1], 0
    s_load_dwordx4 s[20:23], s[0:1], 64
    s_load_dwordx2 s[24:25], s[0:1], 80
    s_getpc_b64 s[98:99]
k_pc:
    v_xor_b32 v2, 0x100, v0
    v_lshlrev_b32 v2, 7, v2
    v_min_u32 v2, k_last-k_pc, v2
    global_load_dword v15, v2, s[98:99]
    v_lshrrev_b32 v2, 6, v0
    v_and_b32 v1, 63, v0
    v_readfirstlane_b32 s70, v2
    s_and_b32 s76, s2, 7
    s_lshr_b32 s77, s2, 3
    s_and_b32 s78, s76, 1
    s_lshl_b32 s78, s78, 2
    s_and_b32 s79, s77, 3
    s_add_u32 s68, s78, s79
    s_xor_b32 s71, s78, 4
    s_lshr_b32 s78, s76, 1
    s_add_u32 s71, s71, s78
    s_lshl_b32 s71, s71, 2
    s_add_u32 s71, s71, s79
    s_lshr_b32 s72, s77, 2
    s_lshl3_add_u32 s69, s78, s72
    s_xor_b32 s72, s72, 1
    v_lshrrev_b32 v3, 4, v1
    v_and_b32 v4, 15, v1
    v_lshlrev_b32 v5, 4, v1
    s_cmp_ge_u32 s70, 4
    s_cbranch_scc1 k_C
    s_setprio 3
    v_lshrrev_b32 v2, 5, v1
    v_and_b32 v7, 7, v1
    s_cmp_eq_u32 s70, 0
    s_cbranch_scc1 k_tx
    s_lshl_b32 s76, s77, 1
    v_lshl_add_u32 v45, v2, 6, s76
    v_bfe_u32 v6, v1, 3, 1
    v_add_u32 v45, v45, v6
    s_cmp_eq_u32 s70, 3
    s_cbranch_scc1 k_tkv
    v_mul_u32_u24 v45, 3584, v45
    v_min_u32 v6, 6, v7
    v_lshl_add_u32 v45, v6, 7, v45
    s_mul_i32 s86, s78, 896
    s_mov_b32 s87, 0x70000
    s_mov_b32 s50, 0x1c0000
    s_cmp_eq_u32 s70, 1
    s_waitcnt lgkmcnt(0)
    s_cselect_b64 s[48:49], s[12:13], s[14:15]
    s_branch k_tgo
k_tx:
    s_lshl3_add_u32 s76, s68, s72
    s_lshl_b32 s86, s76, 15
    v_and_b32 v6, 31, v1
    v_lshlrev_b32 v45, 10, v6
    v_lshl_add_u32 v45, v2, 7, v45
    s_mov_b32 s87, 256
    s_mov_b32 s50, 0x200000
    s_waitcnt lgkmcnt(0)
    s_mov_b64 s[48:49], s[4:5]
    s_branch k_tgo
k_tkv:
    v_mul_u32_u24 v45, 3072, v45
    v_min_u32 v6, 5, v7
    v_lshrrev_b32 v8, 1, v6
    v_lshl_add_u32 v45, v8, 10, v45
    v_and_b32 v6, 1, v6
    v_lshl_add_u32 v45, v6, 7, v45
    s_lshl_b32 s86, s78, 8
    s_mov_b32 s87, 0x60000
    s_mov_b32 s50, 0x180000
    s_waitcnt lgkmcnt(0)
    s_mov_b64 s[48:49], s[6:7]
k_tgo:
    s_and_b32 s49, s49, 0xffff
    s_mov_b32 s51, 0x00020000
    buffer_load_dword v46, v45, s[48:51], s86 offen
    s_add_u32 s86, s86, s87
    s_lshr_b32 s78, s69, 3
    s_and_b32 s74, s69, 7
    s_sub_u32 s76, s74, 2
    s_mul_i32 s77, s76, 96
    s_add_u32 s77, s77, 256
    s_lshr_b32 s79, s74, 2
    s_sub_u32 s79, s74, s79
    s_lshl_b32 s79, s79, 7
    s_and_b32 s75, s74, 3
    s_cmp_lt_u32 s76, 4
    s_cselect_b32 s73, 1, 0
    s_cselect_b32 s74, s77, s79
    s_cselect_b32 s75, s76, s75
    s_mul_i32 s77, s78, 896
    s_add_u32 s74, s74, s77
    s_lshl2_add_u32 s75, s78, s75
    v_lshrrev_b32 v6, 3, v1
    v_xor_b32 v17, v7, v3
    v_xor_b32 v18, 4, v17
    s_lshl2_add_u32 s76, s68, s70
    s_lshl_b32 s76, s76, 16
    v_lshl_add_u32 v19, v6, 10, s76
    v_lshl_add_u32 v20, v17, 4, v19
    v_lshl_add_u32 v21, v18, 4, v19
    v_add_u32 v32, 0x0, v20
    v_add_u32 v33, 0x1c00, v21
    v_add_u32 v34, 0x3800, v20
    v_add_u32 v35, 0x5400, v21
    v_add_u32 v36, 0x8000, v20
    v_add_u32 v37, 0x9c00, v21
    v_add_u32 v38, 0xb800, v20
    v_add_u32 v39, 0xd400, v21
    v_lshrrev_b32 v20, 1, v7
    v_and_b32 v21, 1, v3
    v_xor_b32 v20, v20, v21
    v_and_b32 v22, 1, v1
    s_and_b32 s76, s70, 1
    s_mul_i32 s76, s76, 114688
    s_add_u32 s76, s76, s74
    s_mul_i32 s77, s70, 49152
    s_lshl_b32 s78, s75, 6
    s_add_u32 s77, s77, s78
    s_cmp_ge_u32 s70, 2
    s_cselect_b64 s[12:13], s[14:15], s[12:13]
    s_cmp_eq_u32 s73, 1
    s_cselect_b64 s[36:37], s[6:7], s[12:13]
    s_cselect_b32 s27, 6, 7
    s_cbranch_scc1 k_aB
    v_mul_u32_u24 v19, 3584, v6
    v_lshl_add_u32 v19, v22, 4, v19
    v_add_u32 v19, s76, v19
    v_xor_b32 v21, 2, v20
    v_lshl_add_u32 v40, v20, 5, v19
    v_lshl_add_u32 v21, v21, 5, v19
    v_add_u32 v41, 27648, v21
    v_add_u32 v42, 55296, v40
    v_add_u32 v43, 86016, v21
    v_lshrrev_b32 v19, 2, v1
    v_mul_u32_u24 v19, 3072, v19
    v_bfe_u32 v20, v1, 1, 1
    v_xor_b32 v20, v20, v2
    v_lshl_add_u32 v19, v20, 5, v19
    v_lshl_add_u32 v19, v22, 4, v19
    v_add_u32 v44, s77, v19
    s_branch k_aE
k_aB:
    v_add_u32 v19, 0, v1
    v_mul_u32_u24 v21, 171, v19
    v_lshrrev_b32 v21, 10, v21
    v_mul_u32_u24 v23, 6, v21
    v_sub_u32 v19, v19, v23
    v_lshrrev_b32 v23, 1, v21
    v_xor_b32 v23, v23, v21
    v_and_b32 v23, 4, v23
    v_mul_u32_u24 v23, 3, v23
    v_xor_b32 v21, v21, v23
    v_mul_u32_u24 v21, 3584, v21
    v_lshl_add_u32 v19, v19, 4, v21
    v_add_u32 v40, s76, v19
    s_sub_u32 s76, s76, 1024
    v_add_u32 v19, 64, v1
    v_mul_u32_u24 v21, 171, v19
    v_lshrrev_b32 v21, 10, v21
    v_mul_u32_u24 v23, 6, v21
    v_sub_u32 v19, v19, v23
    v_lshrrev_b32 v23, 1, v21
    v_xor_b32 v23, v23, v21
    v_and_b32 v23, 4, v23
    v_mul_u32_u24 v23, 3, v23
    v_xor_b32 v21, v21, v23
    v_mul_u32_u24 v21, 3584, v21
    v_lshl_add_u32 v19, v19, 4, v21
    v_add_u32 v41, s76, v19
    s_sub_u32 s76, s76, 1024
    v_add_u32 v19, 128, v1
    v_mul_u32_u24 v21, 171, v19
    v_lshrrev_b32 v21, 10, v21
    v_mul_u32_u24 v23, 6, v21
    v_sub_u32 v19, v19, v23
    v_lshrrev_b32 v23, 1, v21
    v_xor_b32 v23, v23, v21
    v_and_b32 v23, 4, v23
    v_mul_u32_u24 v23, 3, v23
    v_xor_b32 v21, v21, v23
    v_mul_u32_u24 v21, 3584, v21
    v_lshl_add_u32 v19, v19, 4, v21
    v_add_u32 v42, s76, v19
    s_sub_u32 s76, s76, 1024
    v_mul_u32_u24 v19, 3072, v6
    v_lshl_add_u32 v19, v22, 4, v19
    v_and_b32 v21, 1, v20
    v_lshl_add_u32 v19, v21, 5, v19
    v_add_u32 v19, s77, v19
    v_lshrrev_b32 v20, 1, v20
    v_xor_b32 v21, 1, v20
    v_lshl_add_u32 v20, v20, 10, v19
    v_lshl_add_u32 v21, v21, 10, v19
    v_add_u32 v43, 1024, v20
    v_add_u32 v44, 25600, v21
k_aE:
    s_lshl_b32 s38, s27, 18
    s_lshl_b32 s27, s27, 15
    s_and_b32 s37, s37, 0xffff
    s_mov_b32 s39, 0x00020000
    s_lshl_b32 s84, s70, 13
    s_mul_i32 s85, s70, 5120
    s_add_u32 s85, s85, 32768
    s_mov_b32 s83, 0
    s_mov_b32 s28, s4
    s_and_b32 s29, s5, 0xffff
    s_mov_b32 s30, 0x200000
    s_mov_b32 s31, 0x00020000
    s_mov_b32 s32, s12
    s_and_b32 s33, s13, 0xffff
    s_mov_b32 s34, 0x1c0000
    s_mov_b32 s35, 0x00020000
    s_mov_b32 s40, s6
    s_and_b32 s41, s7, 0xffff
    s_mov_b32 s42, 0x180000
    s_mov_b32 s43, 0x00020000
    s_add_u32 m0, s84, 53248
    s_movk_i32 s80, 0
    buffer_load_dwordx4 v32, s[28:31], s80 offen offset:0 lds
    buffer_load_dwordx4 v33, s[28:31], s80 offen offset:1024 lds
    buffer_load_dwordx4 v34, s[28:31], s80 offen offset:2048 lds
    buffer_load_dwordx4 v35, s[28:31], s80 offen offset:3072 lds
    s_add_u32 m0, s84, 57344
    s_movk_i32 s80, 0
    buffer_load_dwordx4 v36, s[28:31], s80 offen offset:0 lds
    buffer_load_dwordx4 v37, s[28:31], s80 offen offset:1024 lds
    buffer_load_dwordx4 v38, s[28:31], s80 offen offset:2048 lds
    buffer_load_dwordx4 v39, s[28:31], s80 offen offset:3072 lds
    s_add_u32 m0, s85, 53248
    s_mov_b32 s81, 0
    buffer_load_dwordx4 v40, s[32:35], s81 offen offset:0 lds
    buffer_load_dwordx4 v41, s[32:35], s81 offen offset:1024 lds
    buffer_load_dwordx4 v42, s[32:35], s81 offen offset:2048 lds
    s_add_u32 m0, s85, 56320
    s_mov_b32 s82, 0
    buffer_load_dwordx4 v43, s[36:39], s83 offen lds
    s_add_u32 m0, s85, 57344
    s_add_u32 s83, s83, s27
    buffer_load_dwordx4 v44, s[40:43], s82 offen lds
    s_add_u32 m0, s84, 106496
    s_movk_i32 s80, 128
    buffer_load_dwordx4 v32, s[28:31], s80 offen offset:0 lds
    buffer_load_dwordx4 v33, s[28:31], s80 offen offset:1024 lds
    buffer_load_dwordx4 v34, s[28:31], s80 offen offset:2048 lds
    buffer_load_dwordx4 v35, s[28:31], s80 offen offset:3072 lds
    s_add_u32 m0, s84, 110592
    s_movk_i32 s80, 128
    buffer_load_dwordx4 v36, s[28:31], s80 offen offset:0 lds
    buffer_load_dwordx4 v37, s[28:31], s80 offen offset:1024 lds
    buffer_load_dwordx4 v38, s[28:31], s80 offen offset:2048 lds
    buffer_load_dwordx4 v39, s[28:31], s80 offen offset:3072 lds
    s_add_u32 m0, s85, 106496
    s_mov_b32 s81, 229376
    buffer_load_dwordx4 v40, s[32:35], s81 offen offset:0 lds
    buffer_load_dwordx4 v41, s[32:35], s81 offen offset:1024 lds
    buffer_load_dwordx4 v42, s[32:35], s81 offen offset:2048 lds
    s_add_u32 m0, s85, 109568
    s_mov_b32 s82, 196608
    buffer_load_dwordx4 v43, s[36:39], s83 offen lds
    buffer_load_dword v46, v45, s[48:51], s86 offen
    s_add_u32 s86, s86, s87
    s_lshl_b32 s76, s68, 5
    s_add_u32 s76, s76, s69
    s_lshl2_add_u32 s77, s76, s70
    s_lshl_b32 s77, s77, 11
    s_mov_b32 s44, s18
    s_and_b32 s45, s19, 0xffff
    s_mov_b32 s46, 0x400
    s_mov_b32 s47, 0x00020000
    buffer_load_dwordx4 v[48:51], v5, s[28:31], s77 offen
    buffer_load_dwordx4 v[52:55], v5, s[28:31], s77 offen offset:1024
    buffer_load_dwordx4 v[56:59], v5, s[44:47], 0 offen
    s_mov_b32 s60, s20
    s_and_b32 s61, s21, 0xffff
    s_mov_b32 s62, 0x200000
    s_mov_b32 s63, 0x00020000
    s_lshl4_add_u32 s20, s76, s70
    s_lshl_b32 s20, s20, 3
    s_add_u32 s20, s20, 0xa50000
    s_lshr_b32 s21, s2, 3
    s_lshl2_add_u32 s21, s21, s70
    s_mul_i32 s21, s21, 14336
    s_mov_b32 s44, s24
    s_and_b32 s45, s25, 0xffff
    s_mov_b32 s46, 0x1000000
    s_mov_b32 s47, 0x00020000
    s_cmp_ge_u32 s2, 32
    s_cbranch_scc1 k_ni
    v_mov_b32 v24, -1
    v_mov_b32 v25, -1
    v_mov_b32 v26, -1
    v_mov_b32 v27, -1
    s_lshl2_add_u32 s76, s2, s70
    s_mul_i32 s76, s76, 3072
    s_add_u32 s76, s76, 0xa00000
    buffer_store_dwordx4 v[24:27], v5, s[44:47], s76 offen offset:0 sc1
    buffer_store_dwordx4 v[24:27], v5, s[44:47], s76 offen offset:1024 sc1
    buffer_store_dwordx4 v[24:27], v5, s[44:47], s76 offen offset:2048 sc1
k_ni:
    s_mov_b32 s56, s16
    s_and_b32 s57, s17, 0xffff
    s_mov_b32 s58, 0x1c0000
    s_mov_b32 s59, 0x00020000
    s_mov_b32 s52, s8
    s_and_b32 s53, s9, 0xffff
    s_mov_b32 s54, 0x80000
    s_mov_b32 s55, 0x00020000
    s_mov_b32 s64, s22
    s_and_b32 s65, s23, 0xffff
    s_mov_b32 s66, 0x100
    s_mov_b32 s67, 0x00020000
    s_mul_i32 s92, s70, 12288
    v_lshrrev_b32 v6, 3, v1
    s_lshl_b32 s76, s72, 7
    v_lshl_add_u32 v6, v6, 10, s76
    v_bfe_u32 v7, v1, 1, 2
    v_xor_b32 v7, v7, v3
    v_lshl_add_u32 v6, v7, 5, v6
    v_and_b32 v7, 1, v1
    v_lshl_add_u32 v248, v7, 4, v6
    v_add_u32 v249, 7168, v248
    v_add_u32 v250, 14336, v248
    v_add_u32 v251, 21504, v248
    v_lshrrev_b32 v6, 2, v1
    v_lshl_add_u32 v6, v6, 7, s92
    v_and_b32 v7, 3, v1
    v_lshl_add_u32 v6, v7, 3, v6
    v_bfe_u32 v7, v1, 3, 2
    v_lshl_add_u32 v252, v7, 5, v6
    v_xor_b32 v253, 32, v252
    v_xor_b32 v254, 64, v252
    v_xor_b32 v255, 96, v252
    s_lshr_b32 s76, s70, 1
    s_lshl_b32 s77, s76, 12
    s_add_u32 s78, s77, 98304
    s_cmp_eq_u32 s76, 3
    s_cselect_b32 s77, 49152, s77
    s_and_b32 s76, s70, 1
    s_lshl_b32 s76, s76, 11
    v_lshrrev_b32 v6, 3, v1
    v_and_b32 v7, 7, v1
    v_lshlrev_b32 v7, 1, v7
    v_xor_b32 v7, v7, v6
    v_lshl_add_u32 v6, v6, 8, s76
    v_lshl_add_u32 v6, v7, 4, v6
    v_xor_b32 v7, 16, v6
    v_add_u32 v10, s77, v6
    v_add_u32 v11, s77, v7
    v_add_u32 v12, s78, v6
    v_add_u32 v13, s78, v7
    s_xor_b32 s15, s70, 4
    s_and_b32 s76, s71, 3
    s_add_u32 s76, s76, s72
    s_bitcmp1_b32 s15, 0
    s_cselect_b32 s77, 3, 0
    s_cselect_b32 s78, 0, 4
    s_cselect_b32 s11, 12, 3
    s_cselect_b32 s12, 3, 12
    s_add_u32 s4, s76, 0
    s_and_b32 s4, s4, 3
    s_add_u32 s4, s4, s77
    s_lshl_b32 s4, s4, 12
    s_add_u32 s5, s76, 1
    s_and_b32 s5, s5, 3
    s_add_u32 s5, s5, s77
    s_lshl_b32 s5, s5, 12
    s_add_u32 s6, s76, 2
    s_and_b32 s6, s6, 3
    s_add_u32 s6, s6, s77
    s_lshl_b32 s6, s6, 12
    s_add_u32 s7, s76, 3
    s_and_b32 s7, s7, 3
    s_add_u32 s7, s7, s77
    s_lshl_b32 s7, s7, 12
    s_lshl_b32 s76, s76, 1
    s_lshr_b32 s8, 0x924924, s76
    s_and_b32 s8, s8, 3
    s_add_u32 s8, s8, s78
    s_lshl_b32 s8, s8, 12
    s_lshr_b32 s9, 0x249249, s76
    s_and_b32 s9, s9, 3
    s_add_u32 s9, s9, s78
    s_lshl_b32 s9, s9, 12
    s_lshr_b32 s10, 0x492492, s76
    s_and_b32 s10, s10, 3
    s_add_u32 s10, s10, s78
    s_lshl_b32 s10, s10, 12
    s_lshl_b32 s76, s15, 2
    s_lshl_b32 s11, s11, s76
    s_lshl_b32 s12, s12, s76
    s_lshl_b32 s76, s15, 1
    s_lshl_b32 s13, 3, s76
    s_mul_i32 s89, s15, 229376
    s_mul_i32 s77, s71, 294912
    s_mul_i32 s90, s15, 28672
    s_add_u32 s90, s90, s77
    s_lshl_b32 s14, s15, 13
    s_add_u32 s14, s14, s77
    s_add_u32 s14, s14, 229376
    s_lshl_b32 s93, s71, 8
    s_add_u32 s93, s93, 0xa58000
    v_and_b32 v6, 3, v1
    v_lshl_add_u32 v6, v6, 1, v2
    v_bfe_u32 v7, v1, 2, 3
    v_lshlrev_b32 v7, 2, v7
    v_lshl_add_u32 v16, v6, 7, v7
    v_and_b32 v17, 31, v1
    v_lshlrev_b32 v17, 3, v17
    v_lshlrev_b32 v2, 2, v1
    v_mov_b32 v18, 1
    s_lshl2_add_u32 s76, s75, s70
    s_mul_i32 s77, s68, s73
    s_lshl3_add_u32 s76, s76, s77
    s_lshl_b32 s18, s76, 9
    s_add_u32 s18, s18, 0xa00000
    s_lshl_b32 s19, s76, 7
    s_add_u32 s19, s19, 0xa40000
    s_waitcnt vmcnt(19)
    s_cmp_lt_u32 s2, 32
    s_cbranch_scc1 k_b0
    s_waitcnt vmcnt(16)
k_b0:
    s_barrier
    s_add_u32 m0, s85, 110592
    s_add_u32 s83, s83, s27
    buffer_load_dwordx4 v44, s[40:43], s82 offen lds
    s_add_u32 m0, s84, 0
    s_movk_i32 s80, 256
    buffer_load_dwordx4 v32, s[28:31], s80 offen offset:0 lds
    buffer_load_dwordx4 v33, s[28:31], s80 offen offset:1024 lds
    buffer_load_dwordx4 v34, s[28:31], s80 offen offset:2048 lds
    buffer_load_dwordx4 v35, s[28:31], s80 offen offset:3072 lds
    s_add_u32 m0, s84, 4096
    s_movk_i32 s80, 256
    buffer_load_dwordx4 v36, s[28:31], s80 offen offset:0 lds
    buffer_load_dwordx4 v37, s[28:31], s80 offen offset:1024 lds
    buffer_load_dwordx4 v38, s[28:31], s80 offen offset:2048 lds
    buffer_load_dwordx4 v39, s[28:31], s80 offen offset:3072 lds
    s_add_u32 m0, s85, 0
    s_mov_b32 s81, 458752
    buffer_load_dwordx4 v40, s[32:35], s81 offen offset:0 lds
    buffer_load_dwordx4 v41, s[32:35], s81 offen offset:1024 lds
    buffer_load_dwordx4 v42, s[32:35], s81 offen offset:2048 lds
    s_add_u32 m0, s85, 3072
    s_mov_b32 s82, 393216
    buffer_load_dwordx4 v43, s[36:39], s83 offen lds
    s_add_u32 m0, s85, 4096
    s_add_u32 s83, s83, s27
    buffer_load_dwordx4 v44, s[40:43], s82 offen lds
    s_waitcnt vmcnt(14)
    v_dot2_f32_bf16 v60, v48, v56, 0
    v_dot2_f32_bf16 v61, v52, v56, 0
    v_dot2_f32_bf16 v60, v49, v57, v60
    v_dot2_f32_bf16 v61, v53, v57, v61
    v_dot2_f32_bf16 v60, v50, v58, v60
    v_dot2_f32_bf16 v61, v54, v58, v61
    v_dot2_f32_bf16 v60, v51, v59, v60
    v_dot2_f32_bf16 v61, v55, v59, v61
    s_nop 2
    v_permlane32_swap_b32 v60, v61
    v_add_f32 v60, v60, v61
    s_nop 1
    v_add_f32_dpp v60, v60, v60 row_ror:1 row_mask:0xf bank_mask:0xf
    s_nop 1
    v_add_f32_dpp v60, v60, v60 row_ror:2 row_mask:0xf bank_mask:0xf
    s_nop 1
    v_add_f32_dpp v60, v60, v60 row_ror:4 row_mask:0xf bank_mask:0xf
    s_nop 1
    v_add_f32_dpp v60, v60, v60 row_ror:8 row_mask:0xf bank_mask:0xf
    v_mov_b32 v61, v60
    s_nop 1
    v_permlane16_swap_b32 v60, v61
    v_add_f32 v60, v60, v61
    v_cvt_pk_bf16_f32 v60, v60, v60
    v_lshlrev_b32 v60, 16, v60
    v_mul_f32 v60, 0xbfb8aa3b, v60
    v_exp_f32 v60, v60
    s_nop 0
    v_add_f32 v60, 1.0, v60
    v_rcp_f32 v60, v60
    s_nop 0
    v_cvt_pk_bf16_f32 v60, v60, v60
    v_lshlrev_b32 v60, 16, v60
    v_sub_f32 v61, 1.0, v60
    v_cvt_pk_bf16_f32 v60, v61, v60
    v_mov_b32 v61, v60
    s_nop 1
    v_permlane32_swap_b32 v60, v61
    s_waitcnt vmcnt(13)
    s_barrier
    s_lshr_b32 s76, s2, 5
    s_or_b32 s76, s76, s70
    s_cbranch_scc1 k_na
    s_lshl_b32 s76, s2, 3
    s_mov_b64 exec, 1
    buffer_store_dword v18, off, s[64:67], s76 sc1
    s_mov_b64 exec, -1
k_na:
    s_add_u32 m0, s84, 53248
    s_movk_i32 s80, 384
    buffer_load_dwordx4 v32, s[28:31], s80 offen offset:0 lds
    buffer_load_dwordx4 v33, s[28:31], s80 offen offset:1024 lds
    buffer_load_dwordx4 v34, s[28:31], s80 offen offset:2048 lds
    buffer_load_dwordx4 v35, s[28:31], s80 offen offset:3072 lds
    s_add_u32 m0, s84, 57344
    s_movk_i32 s80, 384
    buffer_load_dwordx4 v36, s[28:31], s80 offen offset:0 lds
    buffer_load_dwordx4 v37, s[28:31], s80 offen offset:1024 lds
    buffer_load_dwordx4 v38, s[28:31], s80 offen offset:2048 lds
    buffer_load_dwordx4 v39, s[28:31], s80 offen offset:3072 lds
    s_add_u32 m0, s85, 53248
    s_mov_b32 s81, 688128
    buffer_load_dwordx4 v40, s[32:35], s81 offen offset:0 lds
    buffer_load_dwordx4 v41, s[32:35], s81 offen offset:1024 lds
    buffer_load_dwordx4 v42, s[32:35], s81 offen offset:2048 lds
    s_add_u32 m0, s85, 56320
    s_mov_b32 s82, 589824
    buffer_load_dwordx4 v43, s[36:39], s83 offen lds
    s_add_u32 m0, s85, 57344
    s_add_u32 s83, s83, s27
    buffer_load_dwordx4 v44, s[40:43], s82 offen lds
    buffer_load_dword v46, v45, s[48:51], s86 offen
    s_add_u32 s86, s86, s87
    s_waitcnt vmcnt(14)
    s_barrier
    s_add_u32 m0, s84, 106496
    s_movk_i32 s80, 512
    buffer_load_dwordx4 v32, s[28:31], s80 offen offset:0 lds
    buffer_load_dwordx4 v33, s[28:31], s80 offen offset:1024 lds
    buffer_load_dwordx4 v34, s[28:31], s80 offen offset:2048 lds
    buffer_load_dwordx4 v35, s[28:31], s80 offen offset:3072 lds
    s_add_u32 m0, s84, 110592
    s_movk_i32 s80, 512
    buffer_load_dwordx4 v36, s[28:31], s80 offen offset:0 lds
    buffer_load_dwordx4 v37, s[28:31], s80 offen offset:1024 lds
    buffer_load_dwordx4 v38, s[28:31], s80 offen offset:2048 lds
    buffer_load_dwordx4 v39, s[28:31], s80 offen offset:3072 lds
    s_add_u32 m0, s85, 106496
    s_mov_b32 s81, 917504
    buffer_load_dwordx4 v40, s[32:35], s81 offen offset:0 lds
    buffer_load_dwordx4 v41, s[32:35], s81 offen offset:1024 lds
    buffer_load_dwordx4 v42, s[32:35], s81 offen offset:2048 lds
    s_add_u32 m0, s85, 109568
    s_mov_b32 s82, 786432
    buffer_load_dwordx4 v43, s[36:39], s83 offen lds
    s_add_u32 m0, s85, 110592
    s_add_u32 s83, s83, s27
    buffer_load_dwordx4 v44, s[40:43], s82 offen lds
    buffer_load_dword v47, v17, s[64:67], 0 offen sc1
    s_waitcnt vmcnt(15)
    s_barrier
    s_waitcnt vmcnt(0)
    v_cmp_eq_u32 vcc, 0, v47
    s_cmp_eq_u64 vcc, 0
    s_cbranch_scc0 k_init
k_init_ok:
    s_mov_b64 exec, 1
    buffer_store_dwordx2 v[60:61], off, s[44:47], s20 sc1
    s_mov_b64 exec, -1
    s_lshl2_add_u32 s20, s68, s70
    s_lshl_b32 s20, s20, 10
    s_add_u32 s20, s20, 0xa50000
    s_add_u32 m0, s84, 0
    s_movk_i32 s80, 640
    buffer_load_dwordx4 v32, s[28:31], s80 offen offset:0 lds
    buffer_load_dwordx4 v33, s[28:31], s80 offen offset:1024 lds
    buffer_load_dwordx4 v34, s[28:31], s80 offen offset:2048 lds
    buffer_load_dwordx4 v35, s[28:31], s80 offen offset:3072 lds
    s_add_u32 m0, s84, 4096
    s_movk_i32 s80, 640
    buffer_load_dwordx4 v36, s[28:31], s80 offen offset:0 lds
    buffer_load_dwordx4 v37, s[28:31], s80 offen offset:1024 lds
    buffer_load_dwordx4 v38, s[28:31], s80 offen offset:2048 lds
    buffer_load_dwordx4 v39, s[28:31], s80 offen offset:3072 lds
    s_add_u32 m0, s85, 0
    s_mov_b32 s81, 1146880
    buffer_load_dwordx4 v40, s[32:35], s81 offen offset:0 lds
    buffer_load_dwordx4 v41, s[32:35], s81 offen offset:1024 lds
    buffer_load_dwordx4 v42, s[32:35], s81 offen offset:2048 lds
    s_add_u32 m0, s85, 3072
    s_mov_b32 s82, 983040
    buffer_load_dwordx4 v43, s[36:39], s83 offen lds
    s_add_u32 m0, s85, 4096
    s_add_u32 s83, s83, s27
    buffer_load_dwordx4 v44, s[40:43], s82 offen lds
    buffer_load_dword v46, v45, s[48:51], s86 offen
    s_add_u32 s86, s86, s87
    s_barrier
    s_add_u32 m0, s84, 53248
    s_movk_i32 s80, 768
    buffer_load_dwordx4 v32, s[28:31], s80 offen offset:0 lds
    buffer_load_dwordx4 v33, s[28:31], s80 offen offset:1024 lds
    buffer_load_dwordx4 v34, s[28:31], s80 offen offset:2048 lds
    buffer_load_dwordx4 v35, s[28:31], s80 offen offset:3072 lds
    s_add_u32 m0, s84, 57344
    s_movk_i32 s80, 768
    buffer_load_dwordx4 v36, s[28:31], s80 offen offset:0 lds
    buffer_load_dwordx4 v37, s[28:31], s80 offen offset:1024 lds
    buffer_load_dwordx4 v38, s[28:31], s80 offen offset:2048 lds
    buffer_load_dwordx4 v39, s[28:31], s80 offen offset:3072 lds
    s_add_u32 m0, s85, 53248
    s_mov_b32 s81, 1376256
    buffer_load_dwordx4 v40, s[32:35], s81 offen offset:0 lds
    buffer_load_dwordx4 v41, s[32:35], s81 offen offset:1024 lds
    buffer_load_dwordx4 v42, s[32:35], s81 offen offset:2048 lds
    s_add_u32 m0, s85, 56320
    s_mov_b32 s82, 1179648
    buffer_load_dwordx4 v43, s[36:39], s83 offen lds
    s_add_u32 m0, s85, 57344
    s_add_u32 s83, s83, s27
    buffer_load_dwordx4 v44, s[40:43], s82 offen lds
    s_mov_b32 s76, 0x73
    v_lshlrev_b32 v9, 2, v3
    v_bfe_u32 v9, s76, v9, 4
    v_lshlrev_b32 v9, 7, v9
    v_lshl_add_u32 v9, v4, 10, v9
    s_lshr_b32 s76, s2, 3
    s_lshl2_add_u32 s76, s76, s70
    s_lshl_b32 s76, s76, 12
    s_mov_b32 exec_lo, 0x3fff3fff
    s_mov_b32 exec_hi, 0x0
    buffer_load_dword v46, v9, s[56:59], s21 offen
    s_mov_b32 exec_lo, 0xf000f
    s_mov_b32 exec_hi, 0x0
    buffer_load_dword v46, v9, s[52:55], s76 offen
    s_mov_b64 exec, -1
    s_waitcnt vmcnt(16)
    s_barrier
    s_add_u32 m0, s84, 106496
    s_movk_i32 s80, 896
    buffer_load_dwordx4 v32, s[28:31], s80 offen offset:0 lds
    buffer_load_dwordx4 v33, s[28:31], s80 offen offset:1024 lds
    buffer_load_dwordx4 v34, s[28:31], s80 offen offset:2048 lds
    buffer_load_dwordx4 v35, s[28:31], s80 offen offset:3072 lds
    s_add_u32 m0, s84, 110592
    s_movk_i32 s80, 896
    buffer_load_dwordx4 v36, s[28:31], s80 offen offset:0 lds
    buffer_load_dwordx4 v37, s[28:31], s80 offen offset:1024 lds
    buffer_load_dwordx4 v38, s[28:31], s80 offen offset:2048 lds
    buffer_load_dwordx4 v39, s[28:31], s80 offen offset:3072 lds
    s_add_u32 m0, s85, 106496
    s_mov_b32 s81, 1605632
    buffer_load_dwordx4 v40, s[32:35], s81 offen offset:0 lds
    buffer_load_dwordx4 v41, s[32:35], s81 offen offset:1024 lds
    buffer_load_dwordx4 v42, s[32:35], s81 offen offset:2048 lds
    s_add_u32 m0, s85, 109568
    s_mov_b32 s82, 1376256
    buffer_load_dwordx4 v43, s[36:39], s83 offen lds
    s_add_u32 m0, s85, 110592
    s_add_u32 s83, s83, s27
    buffer_load_dwordx4 v44, s[40:43], s82 offen lds
    buffer_load_dword v47, v16, s[44:47], s20 offen sc1
    s_waitcnt vmcnt(16)
    s_barrier
    s_lshl_b32 s77, s70, 8
    s_add_u32 s77, s77, 159744
    v_add_u32 v6, s77, v2
    s_waitcnt vmcnt(0)
    v_cmp_eq_u32 vcc, -1, v47
    s_cmp_eq_u64 vcc, 0
    s_cbranch_scc0 k_gs
k_gs_ok:
    ds_write_b32 v6, v47
    s_waitcnt lgkmcnt(0)
    s_add_u32 m0, s92, 0
    s_lshl3_add_u32 s88, s4, s89
    buffer_load_dwordx4 v248, s[56:59], s88 offen offset:0 lds
    buffer_load_dwordx4 v249, s[56:59], s88 offen offset:1024 lds
    buffer_load_dwordx4 v250, s[56:59], s88 offen offset:2048 lds
    buffer_load_dwordx4 v251, s[56:59], s88 offen offset:3072 lds
    s_add_u32 m0, s92, 4096
    s_lshl3_add_u32 s88, s5, s89
    buffer_load_dwordx4 v248, s[56:59], s88 offen offset:0 lds
    buffer_load_dwordx4 v249, s[56:59], s88 offen offset:1024 lds
    buffer_load_dwordx4 v250, s[56:59], s88 offen offset:2048 lds
    buffer_load_dwordx4 v251, s[56:59], s88 offen offset:3072 lds
    s_add_u32 m0, s92, 8192
    s_lshl3_add_u32 s88, s6, s89
    buffer_load_dwordx4 v248, s[56:59], s88 offen offset:0 lds
    buffer_load_dwordx4 v249, s[56:59], s88 offen offset:1024 lds
    buffer_load_dwordx4 v250, s[56:59], s88 offen offset:2048 lds
    buffer_load_dwordx4 v251, s[56:59], s88 offen offset:3072 lds
    s_barrier
    s_add_u32 m0, s92, 49152
    s_lshl3_add_u32 s88, s7, s89
    buffer_load_dwordx4 v248, s[56:59], s88 offen offset:0 lds
    buffer_load_dwordx4 v249, s[56:59], s88 offen offset:1024 lds
    buffer_load_dwordx4 v250, s[56:59], s88 offen offset:2048 lds
    buffer_load_dwordx4 v251, s[56:59], s88 offen offset:3072 lds
    s_add_u32 m0, s92, 53248
    s_lshl3_add_u32 s88, s8, s89
    buffer_load_dwordx4 v248, s[56:59], s88 offen offset:0 lds
    buffer_load_dwordx4 v249, s[56:59], s88 offen offset:1024 lds
    buffer_load_dwordx4 v250, s[56:59], s88 offen offset:2048 lds
    buffer_load_dwordx4 v251, s[56:59], s88 offen offset:3072 lds
    s_waitcnt vmcnt(16)
    ds_read_b64_tr_b16 v[48:49], v252 offset:0
    ds_read_b64_tr_b16 v[50:51], v252 offset:2048
    ds_read_b64_tr_b16 v[52:53], v253 offset:0
    ds_read_b64_tr_b16 v[54:55], v253 offset:2048
    ds_read_b64_tr_b16 v[56:57], v254 offset:0
    ds_read_b64_tr_b16 v[58:59], v254 offset:2048
    ds_read_b64_tr_b16 v[60:61], v255 offset:0
    ds_read_b64_tr_b16 v[62:63], v255 offset:2048
    s_waitcnt lgkmcnt(0)
    s_add_u32 m0, s92, 0
    s_lshl3_add_u32 s88, s9, s89
    buffer_load_dwordx4 v248, s[56:59], s88 offen offset:0 lds
    buffer_load_dwordx4 v249, s[56:59], s88 offen offset:1024 lds
    buffer_load_dwordx4 v250, s[56:59], s88 offen offset:2048 lds
    buffer_load_dwordx4 v251, s[56:59], s88 offen offset:3072 lds
    s_waitcnt vmcnt(16)
    ds_read_b64_tr_b16 v[64:65], v252 offset:4096
    ds_read_b64_tr_b16 v[66:67], v252 offset:6144
    ds_read_b64_tr_b16 v[68:69], v253 offset:4096
    ds_read_b64_tr_b16 v[70:71], v253 offset:6144
    ds_read_b64_tr_b16 v[72:73], v254 offset:4096
    ds_read_b64_tr_b16 v[74:75], v254 offset:6144
    ds_read_b64_tr_b16 v[76:77], v255 offset:4096
    ds_read_b64_tr_b16 v[78:79], v255 offset:6144
    s_waitcnt lgkmcnt(0)
    s_add_u32 m0, s92, 4096
    s_lshl3_add_u32 s88, s10, s89
    buffer_load_dwordx4 v248, s[56:59], s88 offen offset:0 lds
    buffer_load_dwordx4 v249, s[56:59], s88 offen offset:1024 lds
    buffer_load_dwordx4 v250, s[56:59], s88 offen offset:2048 lds
    buffer_load_dwordx4 v251, s[56:59], s88 offen offset:3072 lds
    s_waitcnt vmcnt(16)
    ds_read_b64_tr_b16 v[80:81], v252 offset:8192
    ds_read_b64_tr_b16 v[82:83], v252 offset:10240
    ds_read_b64_tr_b16 v[84:85], v253 offset:8192
    ds_read_b64_tr_b16 v[86:87], v253 offset:10240
    ds_read_b64_tr_b16 v[88:89], v254 offset:8192
    ds_read_b64_tr_b16 v[90:91], v254 offset:10240
    ds_read_b64_tr_b16 v[92:93], v255 offset:8192
    ds_read_b64_tr_b16 v[94:95], v255 offset:10240
    s_waitcnt lgkmcnt(0)
    s_add_u32 m0, s92, 8192
    s_lshl_b32 s88, s15, 16
    s_add_u32 s88, s88, 0x0
    buffer_load_dwordx4 v248, s[52:55], s88 offen offset:0 lds
    buffer_load_dwordx4 v249, s[52:55], s88 offen offset:1024 lds
    buffer_load_dwordx4 v250, s[52:55], s88 offen offset:2048 lds
    buffer_load_dwordx4 v251, s[52:55], s88 offen offset:3072 lds
    v_add_u32 v7, s92, v2
    v_and_b32 v8, 12, v2
    v_bfe_u32 v6, v1, 2, 1
    v_lshl_add_u32 v8, v6, 10, v8
    v_add_u32 v8, s92, v8
    v_lshlrev_b32 v6, 3, v1
    s_barrier
    s_waitcnt vmcnt(0)
    s_cmp_eq_u32 s73, 0
    s_cbranch_scc1 k_nk
    ds_read2st64_b32 v[16:17], v7 offset0:224 offset1:225
    ds_read2st64_b32 v[18:19], v7 offset0:226 offset1:227
    ds_read2st64_b32 v[20:21], v7 offset0:228 offset1:229
    ds_read2st64_b32 v[22:23], v7 offset0:230 offset1:231
    ds_read2st64_b32 v[24:25], v8 offset0:232 offset1:233
    ds_read2st64_b32 v[26:27], v8 offset0:234 offset1:235
    s_waitcnt lgkmcnt(0)
    v_pk_add_f32 v[16:17], v[16:17], v[18:19]
    v_pk_add_f32 v[20:21], v[20:21], v[22:23]
    v_pk_add_f32 v[24:25], v[24:25], v[26:27]
    v_add_f32 v16, v16, v17
    v_add_f32 v17, v20, v21
    v_add_f32 v24, v24, v25
    buffer_store_dwordx2 v[16:17], v6, s[44:47], s18 offen sc1
    s_mov_b64 exec, 0xff
    buffer_store_dword v24, v2, s[44:47], s19 offen sc1
    s_mov_b64 exec, -1
k_nk:
    s_setprio 1
    ds_read_b64_tr_b16 v[96:97], v252 offset:49152
    ds_read_b64_tr_b16 v[98:99], v252 offset:51200
    ds_read_b64_tr_b16 v[100:101], v253 offset:49152
    ds_read_b64_tr_b16 v[102:103], v253 offset:51200
    ds_read_b64_tr_b16 v[104:105], v254 offset:49152
    ds_read_b64_tr_b16 v[106:107], v254 offset:51200
    ds_read_b64_tr_b16 v[108:109], v255 offset:49152
    ds_read_b64_tr_b16 v[110:111], v255 offset:51200
    ds_read_b64_tr_b16 v[112:113], v252 offset:53248
    ds_read_b64_tr_b16 v[114:115], v252 offset:55296
    ds_read_b64_tr_b16 v[116:117], v253 offset:53248
    ds_read_b64_tr_b16 v[118:119], v253 offset:55296
    ds_read_b64_tr_b16 v[120:121], v254 offset:53248
    ds_read_b64_tr_b16 v[122:123], v254 offset:55296
    ds_read_b64_tr_b16 v[124:125], v255 offset:53248
    ds_read_b64_tr_b16 v[126:127], v255 offset:55296
    ds_read_b64_tr_b16 v[128:129], v252 offset:0
    ds_read_b64_tr_b16 v[130:131], v252 offset:2048
    ds_read_b64_tr_b16 v[132:133], v253 offset:0
    ds_read_b64_tr_b16 v[134:135], v253 offset:2048
    ds_read_b64_tr_b16 v[136:137], v254 offset:0
    ds_read_b64_tr_b16 v[138:139], v254 offset:2048
    ds_read_b64_tr_b16 v[140:141], v255 offset:0
    ds_read_b64_tr_b16 v[142:143], v255 offset:2048
    ds_read_b64_tr_b16 v[144:145], v252 offset:4096
    ds_read_b64_tr_b16 v[146:147], v252 offset:6144
    ds_read_b64_tr_b16 v[148:149], v253 offset:4096
    ds_read_b64_tr_b16 v[150:151], v253 offset:6144
    ds_read_b64_tr_b16 v[152:153], v254 offset:4096
    ds_read_b64_tr_b16 v[154:155], v254 offset:6144
    ds_read_b64_tr_b16 v[156:157], v255 offset:4096
    ds_read_b64_tr_b16 v[158:159], v255 offset:6144
    ds_read_b64_tr_b16 v[160:161], v252 offset:8192
    ds_read_b64_tr_b16 v[162:163], v252 offset:10240
    ds_read_b64_tr_b16 v[164:165], v253 offset:8192
    ds_read_b64_tr_b16 v[166:167], v253 offset:10240
    ds_read_b64_tr_b16 v[168:169], v254 offset:8192
    ds_read_b64_tr_b16 v[170:171], v254 offset:10240
    ds_read_b64_tr_b16 v[172:173], v255 offset:8192
    ds_read_b64_tr_b16 v[174:175], v255 offset:10240
    s_waitcnt lgkmcnt(0)
    s_cbranch_scc0 k_nb
    s_barrier
k_nb:
    s_add_u32 m0, s92, 57344
    s_lshl_b32 s88, s15, 16
    s_add_u32 s88, s88, 0x8000
    buffer_load_dwordx4 v248, s[52:55], s88 offen offset:0 lds
    buffer_load_dwordx4 v249, s[52:55], s88 offen offset:1024 lds
    buffer_load_dwordx4 v250, s[52:55], s88 offen offset:2048 lds
    buffer_load_dwordx4 v251, s[52:55], s88 offen offset:3072 lds
    s_add_u32 m0, s92, 49152
    s_lshl3_add_u32 s88, s8, s89
    s_add_u32 s88, s88, 0xfff20000
    buffer_load_dwordx4 v248, s[56:59], s88 offen offset:0 lds
    buffer_load_dwordx4 v249, s[56:59], s88 offen offset:1024 lds
    buffer_load_dwordx4 v250, s[56:59], s88 offen offset:2048 lds
    buffer_load_dwordx4 v251, s[56:59], s88 offen offset:3072 lds
    s_add_u32 m0, s92, 53248
    s_lshl3_add_u32 s88, s9, s89
    s_add_u32 s88, s88, 0xfff20000
    buffer_load_dwordx4 v248, s[56:59], s88 offen offset:0 lds
    buffer_load_dwordx4 v249, s[56:59], s88 offen offset:1024 lds
    buffer_load_dwordx4 v250, s[56:59], s88 offen offset:2048 lds
    buffer_load_dwordx4 v251, s[56:59], s88 offen offset:3072 lds
    s_add_u32 m0, s92, 0
    s_lshl3_add_u32 s88, s10, s89
    s_add_u32 s88, s88, 0xfff20000
    buffer_load_dwordx4 v248, s[56:59], s88 offen offset:0 lds
    buffer_load_dwordx4 v249, s[56:59], s88 offen offset:1024 lds
    buffer_load_dwordx4 v250, s[56:59], s88 offen offset:2048 lds
    buffer_load_dwordx4 v251, s[56:59], s88 offen offset:3072 lds
    s_add_u32 m0, s92, 4096
    s_lshl_b32 s88, s15, 16
    s_add_u32 s88, s88, 0xfffc0000
    buffer_load_dwordx4 v248, s[52:55], s88 offen offset:0 lds
    buffer_load_dwordx4 v249, s[52:55], s88 offen offset:1024 lds
    buffer_load_dwordx4 v250, s[52:55], s88 offen offset:2048 lds
    buffer_load_dwordx4 v251, s[52:55], s88 offen offset:3072 lds
    s_add_u32 m0, s92, 8192
    s_lshl_b32 s88, s15, 16
    s_add_u32 s88, s88, 0xfffc8000
    buffer_load_dwordx4 v248, s[52:55], s88 offen offset:0 lds
    buffer_load_dwordx4 v249, s[52:55], s88 offen offset:1024 lds
    buffer_load_dwordx4 v250, s[52:55], s88 offen offset:2048 lds
    buffer_load_dwordx4 v251, s[52:55], s88 offen offset:3072 lds
    v_lshrrev_b32 v8, 3, v1
    v_and_b32 v31, 28, v2
    v_lshl_add_u32 v8, v8, 7, v31
    s_cmp_lg_u32 s73, 0
    s_cbranch_scc1 k_nq
    buffer_load_dwordx2 v[192:193], v6, s[44:47], s18 offen offset:0 sc1
    buffer_load_dwordx2 v[194:195], v6, s[44:47], s18 offen offset:512 sc1
    buffer_load_dwordx2 v[196:197], v6, s[44:47], s18 offen offset:1024 sc1
    buffer_load_dwordx2 v[198:199], v6, s[44:47], s18 offen offset:1536 sc1
    buffer_load_dwordx2 v[200:201], v6, s[44:47], s18 offen offset:2048 sc1
    buffer_load_dwordx2 v[202:203], v6, s[44:47], s18 offen offset:2560 sc1
    buffer_load_dwordx2 v[204:205], v6, s[44:47], s18 offen offset:3072 sc1
    buffer_load_dwordx2 v[206:207], v6, s[44:47], s18 offen offset:3584 sc1
    buffer_load_dword v208, v8, s[44:47], s19 offen sc1
k_nq:
    s_waitcnt vmcnt(20)
    ds_read_b64_tr_b16 v[176:177], v252 offset:57344
    ds_read_b64_tr_b16 v[178:179], v252 offset:59392
    ds_read_b64_tr_b16 v[180:181], v253 offset:57344
    ds_read_b64_tr_b16 v[182:183], v253 offset:59392
    ds_read_b64_tr_b16 v[184:185], v254 offset:57344
    ds_read_b64_tr_b16 v[186:187], v254 offset:59392
    ds_read_b64_tr_b16 v[188:189], v255 offset:57344
    ds_read_b64_tr_b16 v[190:191], v255 offset:59392
    s_cmp_lg_u32 s73, 0
    s_cbranch_scc1 k_nr
    s_waitcnt vmcnt(0)
    v_max3_u32 v212, v192, v193, v194
    v_max3_u32 v213, v196, v197, v198
    v_max3_u32 v214, v200, v201, v202
    v_max3_u32 v215, v204, v205, v206
    v_max3_u32 v212, v212, v195, v199
    v_max3_u32 v213, v213, v203, v207
    v_max3_u32 v214, v214, v215, v208
    v_max3_u32 v212, v212, v213, v214
    v_cmp_eq_u32 vcc, -1, v212
    s_cmp_eq_u64 vcc, 0
    s_cbranch_scc0 k_ks
k_ks_ok:
    v_add_f32_dpp v208, v208, v208 row_ror:8 row_mask:0xf bank_mask:0xf
    v_pk_add_f32 v[192:193], v[192:193], v[194:195]
    v_pk_add_f32 v[196:197], v[196:197], v[198:199]
    v_pk_add_f32 v[200:201], v[200:201], v[202:203]
    v_pk_add_f32 v[204:205], v[204:205], v[206:207]
    v_mov_b32 v209, v208
    v_pk_add_f32 v[192:193], v[192:193], v[196:197]
    v_pk_add_f32 v[200:201], v[200:201], v[204:205]
    v_permlane16_swap_b32 v208, v209
    v_pk_add_f32 v[192:193], v[192:193], v[200:201]
    v_add_f32 v208, v208, v209
    v_mov_b32 v209, v208
    s_waitcnt lgkmcnt(0)
    ds_write2st64_b32 v7, v192, v193 offset0:224 offset1:225
    v_permlane32_swap_b32 v208, v209
    v_add_f32 v208, v208, v209
    ds_write_b32 v7, v208 offset:57856
k_nr:
    s_waitcnt vmcnt(0)
    s_waitcnt lgkmcnt(0)
    buffer_load_dword v9, v2, s[44:47], s93 offen sc1
    s_barrier
    s_waitcnt vmcnt(0)
    v_cmp_eq_u32 s[94:95], 1, v9
    s_and_b32 s77, s94, s11
    s_cmp_eq_u32 s77, s11
    s_cbranch_scc0 k_f1
k_f1_ok:
    s_setprio 3
    s_add_u32 s91, s90, s4
    buffer_load_dwordx4 v[16:19], v5, s[44:47], s91 offen offset:0 sc1
    buffer_load_dwordx4 v[20:23], v5, s[44:47], s91 offen offset:1024 sc1
    buffer_load_dwordx4 v[24:27], v5, s[44:47], s91 offen offset:2048 sc1
    buffer_load_dwordx4 v[28:31], v5, s[44:47], s91 offen offset:3072 sc1
    s_setprio 2
    s_add_u32 s91, s90, s5
    buffer_load_dwordx4 v[32:35], v5, s[44:47], s91 offen offset:0 sc1
    buffer_load_dwordx4 v[36:39], v5, s[44:47], s91 offen offset:1024 sc1
    buffer_load_dwordx4 v[40:43], v5, s[44:47], s91 offen offset:2048 sc1
    buffer_load_dwordx4 v[44:47], v5, s[44:47], s91 offen offset:3072 sc1
    s_waitcnt vmcnt(4)
    v_swap_b32 v18, v24
    v_swap_b32 v19, v25
    v_swap_b32 v22, v28
    v_swap_b32 v23, v29
    v_mfma_f32_16x16x32_bf16 v[192:195], v[48:51], v[16:19], 0
    v_mfma_f32_16x16x32_bf16 v[196:199], v[48:51], v[24:27], 0
    v_mfma_f32_16x16x32_bf16 v[200:203], v[48:51], v[20:23], 0
    v_mfma_f32_16x16x32_bf16 v[204:207], v[48:51], v[28:31], 0
    v_mfma_f32_16x16x32_bf16 v[208:211], v[52:55], v[16:19], 0
    v_mfma_f32_16x16x32_bf16 v[212:215], v[52:55], v[24:27], 0
    v_mfma_f32_16x16x32_bf16 v[216:219], v[52:55], v[20:23], 0
    v_mfma_f32_16x16x32_bf16 v[220:223], v[52:55], v[28:31], 0
    v_mfma_f32_16x16x32_bf16 v[224:227], v[56:59], v[16:19], 0
    v_mfma_f32_16x16x32_bf16 v[228:231], v[56:59], v[24:27], 0
    v_mfma_f32_16x16x32_bf16 v[232:235], v[56:59], v[20:23], 0
    v_mfma_f32_16x16x32_bf16 v[236:239], v[56:59], v[28:31], 0
    v_mfma_f32_16x16x32_bf16 v[240:243], v[60:63], v[16:19], 0
    v_mfma_f32_16x16x32_bf16 v[244:247], v[60:63], v[24:27], 0
    v_mfma_f32_16x16x32_bf16 v[248:251], v[60:63], v[20:23], 0
    v_mfma_f32_16x16x32_bf16 v[252:255], v[60:63], v[28:31], 0
    s_add_u32 s91, s90, s6
    buffer_load_dwordx4 v[16:19], v5, s[44:47], s91 offen offset:0 sc1
    buffer_load_dwordx4 v[20:23], v5, s[44:47], s91 offen offset:1024 sc1
    buffer_load_dwordx4 v[24:27], v5, s[44:47], s91 offen offset:2048 sc1
    buffer_load_dwordx4 v[28:31], v5, s[44:47], s91 offen offset:3072 sc1
    s_setprio 1
    s_add_u32 s91, s90, s7
    buffer_load_dwordx4 v[48:51], v5, s[44:47], s91 offen offset:0 sc1
    buffer_load_dwordx4 v[52:55], v5, s[44:47], s91 offen offset:1024 sc1
    buffer_load_dwordx4 v[56:59], v5, s[44:47], s91 offen offset:2048 sc1
    buffer_load_dwordx4 v[60:63], v5, s[44:47], s91 offen offset:3072 sc1
    s_waitcnt vmcnt(8)
    v_swap_b32 v34, v40
    v_swap_b32 v35, v41
    v_swap_b32 v38, v44
    v_swap_b32 v39, v45
    v_mfma_f32_16x16x32_bf16 v[192:195], v[64:67], v[32:35], v[192:195]
    v_mfma_f32_16x16x32_bf16 v[196:199], v[64:67], v[40:43], v[196:199]
    v_mfma_f32_16x16x32_bf16 v[200:203], v[64:67], v[36:39], v[200:203]
    v_mfma_f32_16x16x32_bf16 v[204:207], v[64:67], v[44:47], v[204:207]
    v_mfma_f32_16x16x32_bf16 v[208:211], v[68:71], v[32:35], v[208:211]
    v_mfma_f32_16x16x32_bf16 v[212:215], v[68:71], v[40:43], v[212:215]
    v_mfma_f32_16x16x32_bf16 v[216:219], v[68:71], v[36:39], v[216:219]
    v_mfma_f32_16x16x32_bf16 v[220:223], v[68:71], v[44:47], v[220:223]
    v_mfma_f32_16x16x32_bf16 v[224:227], v[72:75], v[32:35], v[224:227]
    v_mfma_f32_16x16x32_bf16 v[228:231], v[72:75], v[40:43], v[228:231]
    v_mfma_f32_16x16x32_bf16 v[232:235], v[72:75], v[36:39], v[232:235]
    v_mfma_f32_16x16x32_bf16 v[236:239], v[72:75], v[44:47], v[236:239]
    v_mfma_f32_16x16x32_bf16 v[240:243], v[76:79], v[32:35], v[240:243]
    v_mfma_f32_16x16x32_bf16 v[244:247], v[76:79], v[40:43], v[244:247]
    v_mfma_f32_16x16x32_bf16 v[248:251], v[76:79], v[36:39], v[248:251]
    v_mfma_f32_16x16x32_bf16 v[252:255], v[76:79], v[44:47], v[252:255]
    s_and_b32 s77, s94, s12
    s_cmp_eq_u32 s77, s12
    s_cbranch_scc0 k_f2
k_f2_ok:
    s_add_u32 s91, s90, s8
    buffer_load_dwordx4 v[32:35], v5, s[44:47], s91 offen offset:0 sc1
    buffer_load_dwordx4 v[36:39], v5, s[44:47], s91 offen offset:1024 sc1
    buffer_load_dwordx4 v[40:43], v5, s[44:47], s91 offen offset:2048 sc1
    buffer_load_dwordx4 v[44:47], v5, s[44:47], s91 offen offset:3072 sc1
    s_add_u32 s91, s90, s9
    buffer_load_dwordx4 v[64:67], v5, s[44:47], s91 offen offset:0 sc1
    buffer_load_dwordx4 v[68:71], v5, s[44:47], s91 offen offset:1024 sc1
    buffer_load_dwordx4 v[72:75], v5, s[44:47], s91 offen offset:2048 sc1
    buffer_load_dwordx4 v[76:79], v5, s[44:47], s91 offen offset:3072 sc1
    s_waitcnt vmcnt(12)
    v_swap_b32 v18, v24
    v_swap_b32 v19, v25
    v_swap_b32 v22, v28
    v_swap_b32 v23, v29
    v_mfma_f32_16x16x32_bf16 v[192:195], v[80:83], v[16:19], v[192:195]
    v_mfma_f32_16x16x32_bf16 v[196:199], v[80:83], v[24:27], v[196:199]
    v_mfma_f32_16x16x32_bf16 v[200:203], v[80:83], v[20:23], v[200:203]
    v_mfma_f32_16x16x32_bf16 v[204:207], v[80:83], v[28:31], v[204:207]
    v_mfma_f32_16x16x32_bf16 v[208:211], v[84:87], v[16:19], v[208:211]
    v_mfma_f32_16x16x32_bf16 v[212:215], v[84:87], v[24:27], v[212:215]
    v_mfma_f32_16x16x32_bf16 v[216:219], v[84:87], v[20:23], v[216:219]
    v_mfma_f32_16x16x32_bf16 v[220:223], v[84:87], v[28:31], v[220:223]
    v_mfma_f32_16x16x32_bf16 v[224:227], v[88:91], v[16:19], v[224:227]
    v_mfma_f32_16x16x32_bf16 v[228:231], v[88:91], v[24:27], v[228:231]
    v_mfma_f32_16x16x32_bf16 v[232:235], v[88:91], v[20:23], v[232:235]
    v_mfma_f32_16x16x32_bf16 v[236:239], v[88:91], v[28:31], v[236:239]
    v_mfma_f32_16x16x32_bf16 v[240:243], v[92:95], v[16:19], v[240:243]
    v_mfma_f32_16x16x32_bf16 v[244:247], v[92:95], v[24:27], v[244:247]
    v_mfma_f32_16x16x32_bf16 v[248:251], v[92:95], v[20:23], v[248:251]
    v_mfma_f32_16x16x32_bf16 v[252:255], v[92:95], v[28:31], v[252:255]
    s_setprio 0
    s_add_u32 s91, s90, s10
    buffer_load_dwordx4 v[16:19], v5, s[44:47], s91 offen offset:0 sc1
    buffer_load_dwordx4 v[20:23], v5, s[44:47], s91 offen offset:1024 sc1
    buffer_load_dwordx4 v[24:27], v5, s[44:47], s91 offen offset:2048 sc1
    buffer_load_dwordx4 v[28:31], v5, s[44:47], s91 offen offset:3072 sc1
    s_waitcnt vmcnt(12)
    v_swap_b32 v50, v56
    v_swap_b32 v51, v57
    v_swap_b32 v54, v60
    v_swap_b32 v55, v61
    v_mfma_f32_16x16x32_bf16 v[192:195], v[96:99], v[48:51], v[192:195]
    v_mfma_f32_16x16x32_bf16 v[196:199], v[96:99], v[56:59], v[196:199]
    v_mfma_f32_16x16x32_bf16 v[200:203], v[96:99], v[52:55], v[200:203]
    v_mfma_f32_16x16x32_bf16 v[204:207], v[96:99], v[60:63], v[204:207]
    v_mfma_f32_16x16x32_bf16 v[208:211], v[100:103], v[48:51], v[208:211]
    v_mfma_f32_16x16x32_bf16 v[212:215], v[100:103], v[56:59], v[212:215]
    v_mfma_f32_16x16x32_bf16 v[216:219], v[100:103], v[52:55], v[216:219]
    v_mfma_f32_16x16x32_bf16 v[220:223], v[100:103], v[60:63], v[220:223]
    v_mfma_f32_16x16x32_bf16 v[224:227], v[104:107], v[48:51], v[224:227]
    v_mfma_f32_16x16x32_bf16 v[228:231], v[104:107], v[56:59], v[228:231]
    v_mfma_f32_16x16x32_bf16 v[232:235], v[104:107], v[52:55], v[232:235]
    v_mfma_f32_16x16x32_bf16 v[236:239], v[104:107], v[60:63], v[236:239]
    v_mfma_f32_16x16x32_bf16 v[240:243], v[108:111], v[48:51], v[240:243]
    v_mfma_f32_16x16x32_bf16 v[244:247], v[108:111], v[56:59], v[244:247]
    v_mfma_f32_16x16x32_bf16 v[248:251], v[108:111], v[52:55], v[248:251]
    v_mfma_f32_16x16x32_bf16 v[252:255], v[108:111], v[60:63], v[252:255]
    buffer_load_dword v9, v2, s[44:47], s93 offen sc1
    s_waitcnt vmcnt(9)
    v_swap_b32 v34, v40
    v_swap_b32 v35, v41
    v_swap_b32 v38, v44
    v_swap_b32 v39, v45
    v_mfma_f32_16x16x32_bf16 v[192:195], v[112:115], v[32:35], v[192:195]
    v_mfma_f32_16x16x32_bf16 v[196:199], v[112:115], v[40:43], v[196:199]
    v_mfma_f32_16x16x32_bf16 v[200:203], v[112:115], v[36:39], v[200:203]
    v_mfma_f32_16x16x32_bf16 v[204:207], v[112:115], v[44:47], v[204:207]
    v_mfma_f32_16x16x32_bf16 v[208:211], v[116:119], v[32:35], v[208:211]
    v_mfma_f32_16x16x32_bf16 v[212:215], v[116:119], v[40:43], v[212:215]
    v_mfma_f32_16x16x32_bf16 v[216:219], v[116:119], v[36:39], v[216:219]
    v_mfma_f32_16x16x32_bf16 v[220:223], v[116:119], v[44:47], v[220:223]
    v_mfma_f32_16x16x32_bf16 v[224:227], v[120:123], v[32:35], v[224:227]
    v_mfma_f32_16x16x32_bf16 v[228:231], v[120:123], v[40:43], v[228:231]
    v_mfma_f32_16x16x32_bf16 v[232:235], v[120:123], v[36:39], v[232:235]
    v_mfma_f32_16x16x32_bf16 v[236:239], v[120:123], v[44:47], v[236:239]
    v_mfma_f32_16x16x32_bf16 v[240:243], v[124:127], v[32:35], v[240:243]
    v_mfma_f32_16x16x32_bf16 v[244:247], v[124:127], v[40:43], v[244:247]
    v_mfma_f32_16x16x32_bf16 v[248:251], v[124:127], v[36:39], v[248:251]
    v_mfma_f32_16x16x32_bf16 v[252:255], v[124:127], v[44:47], v[252:255]
    s_waitcnt vmcnt(0)
    v_cmp_eq_u32 s[94:95], 1, v9
    s_and_b32 s77, s95, s13
    s_cmp_eq_u32 s77, s13
    s_cbranch_scc0 k_f3
k_f3_ok:
    s_add_u32 s91, s14, 0
    buffer_load_dwordx4 v[80:83], v5, s[44:47], s91 offen offset:0 sc1
    buffer_load_dwordx4 v[84:87], v5, s[44:47], s91 offen offset:1024 sc1
    buffer_load_dwordx4 v[88:91], v5, s[44:47], s91 offen offset:2048 sc1
    buffer_load_dwordx4 v[92:95], v5, s[44:47], s91 offen offset:3072 sc1
    s_add_u32 s91, s14, 4096
    buffer_load_dwordx4 v[48:51], v5, s[44:47], s91 offen offset:0 sc1
    buffer_load_dwordx4 v[52:55], v5, s[44:47], s91 offen offset:1024 sc1
    buffer_load_dwordx4 v[56:59], v5, s[44:47], s91 offen offset:2048 sc1
    buffer_load_dwordx4 v[60:63], v5, s[44:47], s91 offen offset:3072 sc1
    v_swap_b32 v66, v72
    v_swap_b32 v67, v73
    v_swap_b32 v70, v76
    v_swap_b32 v71, v77
    v_mfma_f32_16x16x32_bf16 v[192:195], v[128:131], v[64:67], v[192:195]
    v_mfma_f32_16x16x32_bf16 v[196:199], v[128:131], v[72:75], v[196:199]
    v_mfma_f32_16x16x32_bf16 v[200:203], v[128:131], v[68:71], v[200:203]
    v_mfma_f32_16x16x32_bf16 v[204:207], v[128:131], v[76:79], v[204:207]
    v_mfma_f32_16x16x32_bf16 v[208:211], v[132:135], v[64:67], v[208:211]
    v_mfma_f32_16x16x32_bf16 v[212:215], v[132:135], v[72:75], v[212:215]
    v_mfma_f32_16x16x32_bf16 v[216:219], v[132:135], v[68:71], v[216:219]
    v_mfma_f32_16x16x32_bf16 v[220:223], v[132:135], v[76:79], v[220:223]
    v_mfma_f32_16x16x32_bf16 v[224:227], v[136:139], v[64:67], v[224:227]
    v_mfma_f32_16x16x32_bf16 v[228:231], v[136:139], v[72:75], v[228:231]
    v_mfma_f32_16x16x32_bf16 v[232:235], v[136:139], v[68:71], v[232:235]
    v_mfma_f32_16x16x32_bf16 v[236:239], v[136:139], v[76:79], v[236:239]
    v_mfma_f32_16x16x32_bf16 v[240:243], v[140:143], v[64:67], v[240:243]
    v_mfma_f32_16x16x32_bf16 v[244:247], v[140:143], v[72:75], v[244:247]
    v_mfma_f32_16x16x32_bf16 v[248:251], v[140:143], v[68:71], v[248:251]
    v_mfma_f32_16x16x32_bf16 v[252:255], v[140:143], v[76:79], v[252:255]
    v_swap_b32 v18, v24
    v_swap_b32 v19, v25
    v_swap_b32 v22, v28
    v_swap_b32 v23, v29
    v_mfma_f32_16x16x32_bf16 v[192:195], v[144:147], v[16:19], v[192:195]
    v_mfma_f32_16x16x32_bf16 v[196:199], v[144:147], v[24:27], v[196:199]
    v_mfma_f32_16x16x32_bf16 v[200:203], v[144:147], v[20:23], v[200:203]
    v_mfma_f32_16x16x32_bf16 v[204:207], v[144:147], v[28:31], v[204:207]
    v_mfma_f32_16x16x32_bf16 v[208:211], v[148:151], v[16:19], v[208:211]
    v_mfma_f32_16x16x32_bf16 v[212:215], v[148:151], v[24:27], v[212:215]
    v_mfma_f32_16x16x32_bf16 v[216:219], v[148:151], v[20:23], v[216:219]
    v_mfma_f32_16x16x32_bf16 v[220:223], v[148:151], v[28:31], v[220:223]
    v_mfma_f32_16x16x32_bf16 v[224:227], v[152:155], v[16:19], v[224:227]
    v_mfma_f32_16x16x32_bf16 v[228:231], v[152:155], v[24:27], v[228:231]
    v_mfma_f32_16x16x32_bf16 v[232:235], v[152:155], v[20:23], v[232:235]
    v_mfma_f32_16x16x32_bf16 v[236:239], v[152:155], v[28:31], v[236:239]
    v_mfma_f32_16x16x32_bf16 v[240:243], v[156:159], v[16:19], v[240:243]
    v_mfma_f32_16x16x32_bf16 v[244:247], v[156:159], v[24:27], v[244:247]
    v_mfma_f32_16x16x32_bf16 v[248:251], v[156:159], v[20:23], v[248:251]
    v_mfma_f32_16x16x32_bf16 v[252:255], v[156:159], v[28:31], v[252:255]
    s_waitcnt vmcnt(4)
    v_swap_b32 v82, v88
    v_swap_b32 v83, v89
    v_swap_b32 v86, v92
    v_swap_b32 v87, v93
    v_mfma_f32_16x16x32_bf16 v[192:195], v[160:163], v[80:83], v[192:195]
    v_mfma_f32_16x16x32_bf16 v[196:199], v[160:163], v[88:91], v[196:199]
    v_mfma_f32_16x16x32_bf16 v[200:203], v[160:163], v[84:87], v[200:203]
    v_mfma_f32_16x16x32_bf16 v[204:207], v[160:163], v[92:95], v[204:207]
    v_mfma_f32_16x16x32_bf16 v[208:211], v[164:167], v[80:83], v[208:211]
    v_mfma_f32_16x16x32_bf16 v[212:215], v[164:167], v[88:91], v[212:215]
    v_mfma_f32_16x16x32_bf16 v[216:219], v[164:167], v[84:87], v[216:219]
    v_mfma_f32_16x16x32_bf16 v[220:223], v[164:167], v[92:95], v[220:223]
    v_mfma_f32_16x16x32_bf16 v[224:227], v[168:171], v[80:83], v[224:227]
    v_mfma_f32_16x16x32_bf16 v[228:231], v[168:171], v[88:91], v[228:231]
    v_mfma_f32_16x16x32_bf16 v[232:235], v[168:171], v[84:87], v[232:235]
    v_mfma_f32_16x16x32_bf16 v[236:239], v[168:171], v[92:95], v[236:239]
    v_mfma_f32_16x16x32_bf16 v[240:243], v[172:175], v[80:83], v[240:243]
    v_mfma_f32_16x16x32_bf16 v[244:247], v[172:175], v[88:91], v[244:247]
    v_mfma_f32_16x16x32_bf16 v[248:251], v[172:175], v[84:87], v[248:251]
    v_mfma_f32_16x16x32_bf16 v[252:255], v[172:175], v[92:95], v[252:255]
    s_lshl_b32 s76, s70, 14
    s_add_u32 s76, s76, 98304
    v_and_b32 v6, 7, v1
    v_xor_b32 v6, v6, v3
    v_lshl_add_u32 v7, v4, 8, s76
    v_lshl_add_u32 v8, v6, 4, v7
    v_xor_b32 v9, 64, v8
    s_waitcnt vmcnt(0)
    v_swap_b32 v50, v56
    v_swap_b32 v51, v57
    v_swap_b32 v54, v60
    v_swap_b32 v55, v61
    v_mfma_f32_16x16x32_bf16 v[192:195], v[176:179], v[48:51], v[192:195]
    v_mfma_f32_16x16x32_bf16 v[196:199], v[176:179], v[56:59], v[196:199]
    v_mfma_f32_16x16x32_bf16 v[200:203], v[176:179], v[52:55], v[200:203]
    v_mfma_f32_16x16x32_bf16 v[204:207], v[176:179], v[60:63], v[204:207]
    s_nop 4
    ds_write_b128 v8, v[192:195] offset:0
    v_mfma_f32_16x16x32_bf16 v[208:211], v[180:183], v[48:51], v[208:211]
    ds_write_b128 v8, v[196:199] offset:4096
    v_mfma_f32_16x16x32_bf16 v[212:215], v[180:183], v[56:59], v[212:215]
    ds_write_b128 v8, v[200:203] offset:8192
    v_mfma_f32_16x16x32_bf16 v[216:219], v[180:183], v[52:55], v[216:219]
    ds_write_b128 v8, v[204:207] offset:12288
    v_mfma_f32_16x16x32_bf16 v[220:223], v[180:183], v[60:63], v[220:223]
    s_nop 1
    ds_write_b128 v9, v[208:211] offset:0
    v_mfma_f32_16x16x32_bf16 v[224:227], v[184:187], v[48:51], v[224:227]
    ds_write_b128 v9, v[212:215] offset:4096
    v_mfma_f32_16x16x32_bf16 v[228:231], v[184:187], v[56:59], v[228:231]
    ds_write_b128 v9, v[216:219] offset:8192
    v_mfma_f32_16x16x32_bf16 v[232:235], v[184:187], v[52:55], v[232:235]
    ds_write_b128 v9, v[220:223] offset:12288
    v_mfma_f32_16x16x32_bf16 v[236:239], v[184:187], v[60:63], v[236:239]
    s_nop 1
    ds_write_b128 v8, v[224:227] offset:128
    v_mfma_f32_16x16x32_bf16 v[240:243], v[188:191], v[48:51], v[240:243]
    ds_write_b128 v8, v[228:231] offset:4224
    v_mfma_f32_16x16x32_bf16 v[244:247], v[188:191], v[56:59], v[244:247]
    ds_write_b128 v8, v[232:235] offset:8320
    v_mfma_f32_16x16x32_bf16 v[248:251], v[188:191], v[52:55], v[248:251]
    ds_write_b128 v8, v[236:239] offset:12416
    v_mfma_f32_16x16x32_bf16 v[252:255], v[188:191], v[60:63], v[252:255]
    s_nop 1
    ds_write_b128 v9, v[240:243] offset:128
    s_nop 0
    ds_write_b128 v9, v[244:247] offset:4224
    s_nop 0
    ds_write_b128 v9, v[248:251] offset:8320
    s_nop 0
    ds_write_b128 v9, v[252:255] offset:12416
    s_waitcnt lgkmcnt(0)
    s_barrier
    s_branch k_final
k_C:
    s_sub_u32 s27, s70, 4
    s_waitcnt lgkmcnt(0)
    s_mov_b32 s44, s24
    s_and_b32 s45, s25, 0xffff
    s_mov_b32 s46, 0x1000000
    s_mov_b32 s47, 0x00020000
    s_lshr_b32 s78, s69, 3
    s_and_b32 s74, s69, 7
    s_sub_u32 s76, s74, 2
    s_mul_i32 s77, s76, 96
    s_add_u32 s77, s77, 256
    s_lshr_b32 s79, s74, 2
    s_sub_u32 s79, s74, s79
    s_lshl_b32 s79, s79, 7
    s_and_b32 s75, s74, 3
    s_cmp_lt_u32 s76, 4
    s_cselect_b32 s73, 1, 0
    s_cselect_b32 s74, s77, s79
    s_cselect_b32 s75, s76, s75
    s_mul_i32 s77, s78, 896
    s_add_u32 s74, s74, s77
    s_lshl2_add_u32 s75, s78, s75
    v_lshlrev_b32 v2, 2, v1
    s_lshl_b32 s76, s27, 13
    s_add_u32 s76, s76, 53248
    v_lshl_add_u32 v16, v4, 7, s76
    v_bfe_u32 v17, v4, 1, 3
    v_xor_b32 v17, v17, v3
    v_lshl_add_u32 v84, v17, 4, v16
    v_xor_b32 v85, 64, v84
    v_and_b32 v17, 3, v4
    v_lshlrev_b32 v21, 3, v17
    v_add_u32 v21, 86016, v21
    v_lshrrev_b32 v22, 1, v3
    v_mul_u32_u24 v16, 5120, v22
    v_add_u32 v16, v16, v21
    v_and_b32 v17, 1, v3
    v_lshrrev_b32 v23, 2, v4
    v_lshl_add_u32 v18, v17, 3, v23
    v_bfe_u32 v20, v1, 3, 2
    s_lshl2_add_u32 s76, s68, s27
    s_mul_i32 s32, s76, 294912
    s_lshl_b32 s83, s74, 6
    s_add_u32 s83, s83, s32
    s_add_u32 s33, s83, 4096
    s_lshl_b32 s34, s76, 8
    s_add_u32 s34, s34, 0xa58000
    s_lshl2_add_u32 s35, s75, s34
    s_lshl2_add_u32 s34, s69, s34
    s_lshl_b32 s76, s75, 12
    s_add_u32 s32, s32, s76
    s_add_u32 s32, s32, 229376
    s_mov_b32 s84, 0x3fb8aa3b
    s_mov_b32 s86, 0x358637bd
    s_mov_b32 s85, 0x3fb8aa3b
    s_mov_b32 s87, 0x358637bd
    s_mov_b32 s82, 0
    s_mov_b32 s81, 0
    s_mov_b32 s56, s16
    s_and_b32 s57, s17, 0xffff
    s_mov_b32 s58, 0x1c0000
    s_mov_b32 s59, 0x00020000
    s_mov_b32 s52, s8
    s_and_b32 s53, s9, 0xffff
    s_mov_b32 s54, 0x80000
    s_mov_b32 s55, 0x00020000
    s_mov_b32 s60, s20
    s_and_b32 s61, s21, 0xffff
    s_mov_b32 s62, 0x200000
    s_mov_b32 s63, 0x00020000
    s_lshl_b32 s92, s27, 14
    s_add_u32 s92, s92, 98304
    s_lshr_b32 s76, s70, 1
    s_lshl_b32 s77, s76, 12
    s_add_u32 s78, s77, 98304
    s_cmp_eq_u32 s76, 3
    s_cselect_b32 s77, 49152, s77
    s_and_b32 s76, s70, 1
    s_lshl_b32 s76, s76, 11
    v_lshrrev_b32 v6, 3, v1
    v_and_b32 v7, 7, v1
    v_lshlrev_b32 v7, 1, v7
    v_xor_b32 v7, v7, v6
    v_lshl_add_u32 v6, v6, 8, s76
    v_lshl_add_u32 v6, v7, 4, v6
    v_xor_b32 v7, 16, v6
    v_add_u32 v10, s77, v6
    v_add_u32 v11, s77, v7
    v_add_u32 v12, s78, v6
    v_add_u32 v13, s78, v7
    s_lshl_b32 s79, s27, 8
    s_add_u32 s76, s79, 159744
    v_lshl_add_u32 v93, v4, 4, s76
    v_mov_b32 v128, 0
    v_mov_b32 v129, 0
    v_mov_b32 v130, 0
    v_mov_b32 v131, 0
    v_mov_b32 v132, 0
    v_mov_b32 v133, 0
    v_mov_b32 v134, 0
    v_mov_b32 v135, 0
    v_mov_b32 v136, 0
    v_mov_b32 v137, 0
    v_mov_b32 v138, 0
    v_mov_b32 v139, 0
    v_mov_b32 v140, 0
    v_mov_b32 v141, 0
    v_mov_b32 v142, 0
    v_mov_b32 v143, 0
    v_mov_b32 v144, 0
    v_mov_b32 v145, 0
    v_mov_b32 v146, 0
    v_mov_b32 v147, 0
    v_mov_b32 v148, 0
    v_mov_b32 v149, 0
    v_mov_b32 v150, 0
    v_mov_b32 v151, 0
    v_mov_b32 v152, 0
    v_mov_b32 v153, 0
    v_mov_b32 v154, 0
    v_mov_b32 v155, 0
    v_mov_b32 v156, 0
    v_mov_b32 v157, 0
    v_mov_b32 v158, 0
    v_mov_b32 v159, 0
    v_mov_b32 v160, 0
    v_mov_b32 v161, 0
    v_mov_b32 v162, 0
    v_mov_b32 v163, 0
    v_mov_b32 v164, 0
    v_mov_b32 v165, 0
    v_mov_b32 v166, 0
    v_mov_b32 v167, 0
    v_mov_b32 v168, 0
    v_mov_b32 v169, 0
    v_mov_b32 v170, 0
    v_mov_b32 v171, 0
    v_mov_b32 v172, 0
    v_mov_b32 v173, 0
    v_mov_b32 v174, 0
    v_mov_b32 v175, 0
    v_mov_b32 v176, 0
    v_mov_b32 v177, 0
    v_mov_b32 v178, 0
    v_mov_b32 v179, 0
    v_mov_b32 v180, 0
    v_mov_b32 v181, 0
    v_mov_b32 v182, 0
    v_mov_b32 v183, 0
    v_mov_b32 v184, 0
    v_mov_b32 v185, 0
    v_mov_b32 v186, 0
    v_mov_b32 v187, 0
    v_mov_b32 v188, 0
    v_mov_b32 v189, 0
    v_mov_b32 v190, 0
    v_mov_b32 v191, 0
    v_mov_b32 v192, 0
    v_mov_b32 v193, 0
    v_mov_b32 v194, 0
    v_mov_b32 v195, 0
    v_mov_b32 v196, 0
    v_mov_b32 v197, 0
    v_mov_b32 v198, 0
    v_mov_b32 v199, 0
    v_mov_b32 v200, 0
    v_mov_b32 v201, 0
    v_mov_b32 v202, 0
    v_mov_b32 v203, 0
    v_mov_b32 v204, 0
    v_mov_b32 v205, 0
    v_mov_b32 v206, 0
    v_mov_b32 v207, 0
    v_mov_b32 v208, 0
    v_mov_b32 v209, 0
    v_mov_b32 v210, 0
    v_mov_b32 v211, 0
    v_mov_b32 v212, 0
    v_mov_b32 v213, 0
    v_mov_b32 v214, 0
    v_mov_b32 v215, 0
    v_mov_b32 v216, 0
    v_mov_b32 v217, 0
    v_mov_b32 v218, 0
    v_mov_b32 v219, 0
    v_mov_b32 v220, 0
    v_mov_b32 v221, 0
    v_mov_b32 v222, 0
    v_mov_b32 v223, 0
    s_cmp_eq_u32 s73, 1
    s_cselect_b32 s76, 1.0, 0
    s_cselect_b32 s77, 0, 1.0
    v_mov_b32 v96, s76
    v_mov_b32 v224, s77
    v_mov_b32 v97, s76
    v_mov_b32 v225, s77
    v_mov_b32 v98, s76
    v_mov_b32 v226, s77
    v_mov_b32 v99, s76
    v_mov_b32 v227, s77
    v_mov_b32 v100, s76
    v_mov_b32 v228, s77
    v_mov_b32 v101, s76
    v_mov_b32 v229, s77
    v_mov_b32 v102, s76
    v_mov_b32 v230, s77
    v_mov_b32 v103, s76
    v_mov_b32 v231, s77
    v_mov_b32 v104, s76
    v_mov_b32 v232, s77
    v_mov_b32 v105, s76
    v_mov_b32 v233, s77
    v_mov_b32 v106, s76
    v_mov_b32 v234, s77
    v_mov_b32 v107, s76
    v_mov_b32 v235, s77
    v_mov_b32 v108, s76
    v_mov_b32 v236, s77
    v_mov_b32 v109, s76
    v_mov_b32 v237, s77
    v_mov_b32 v110, s76
    v_mov_b32 v238, s77
    v_mov_b32 v111, s76
    v_mov_b32 v239, s77
    v_mov_b32 v112, s76
    v_mov_b32 v240, s77
    v_mov_b32 v113, s76
    v_mov_b32 v241, s77
    v_mov_b32 v114, s76
    v_mov_b32 v242, s77
    v_mov_b32 v115, s76
    v_mov_b32 v243, s77
    v_mov_b32 v116, s76
    v_mov_b32 v244, s77
    v_mov_b32 v117, s76
    v_mov_b32 v245, s77
    v_mov_b32 v118, s76
    v_mov_b32 v246, s77
    v_mov_b32 v119, s76
    v_mov_b32 v247, s77
    v_mov_b32 v120, s76
    v_mov_b32 v248, s77
    v_mov_b32 v121, s76
    v_mov_b32 v249, s77
    v_mov_b32 v122, s76
    v_mov_b32 v250, s77
    v_mov_b32 v123, s76
    v_mov_b32 v251, s77
    v_mov_b32 v124, s76
    v_mov_b32 v252, s77
    v_mov_b32 v125, s76
    v_mov_b32 v253, s77
    v_mov_b32 v126, s76
    v_mov_b32 v254, s77
    v_mov_b32 v127, s76
    v_mov_b32 v255, s77
    s_cbranch_scc1 k_sB
    v_lshl_add_u32 v19, v18, 6, v16
    v_lshl_add_u32 v90, v17, 5, v19
    v_add_u32 v90, 4096, v90
    v_xor_b32 v91, 32, v90
    v_lshl_add_u32 v18, v22, 4, v18
    v_lshl_add_u32 v19, v18, 7, v21
    s_branch k_sE
k_sB:
    v_lshl_add_u32 v19, v17, 2, v23
    v_lshl_add_u32 v19, v22, 4, v19
    v_mul_u32_u24 v19, 96, v19
    v_add_u32 v90, v19, v21
    v_mul_u32_u24 v19, 12288, v3
    v_lshl_add_u32 v19, v4, 4, v19
    s_add_u32 s76, s79, 57344
    v_add_u32 v92, s76, v19
    v_lshl_add_u32 v19, v18, 7, v16
    v_add_u32 v19, 3072, v19
k_sE:
    v_lshl_add_u32 v86, v20, 5, v19
    v_xor_b32 v87, 32, v86
    v_xor_b32 v88, 64, v86
    v_xor_b32 v89, 96, v86
    s_lshl2_add_u32 s76, s2, s27
    s_mul_i32 s77, s76, 1792
    s_add_u32 s16, s16, s77
    s_addc_u32 s17, s17, 0
    s_lshl_b32 s77, s76, 9
    s_add_u32 s8, s8, s77
    s_addc_u32 s9, s9, 0
    s_load_dword s3, s[16:17], 0x0
    s_load_dword s3, s[16:17], 0x40
    s_load_dword s3, s[16:17], 0x80
    s_load_dword s3, s[16:17], 0xc0
    s_load_dword s3, s[16:17], 0x100
    s_load_dword s3, s[16:17], 0x140
    s_load_dword s3, s[16:17], 0x180
    s_load_dword s3, s[16:17], 0x1c0
    s_load_dword s3, s[16:17], 0x200
    s_load_dword s3, s[16:17], 0x240
    s_load_dword s3, s[16:17], 0x280
    s_load_dword s3, s[16:17], 0x2c0
    s_load_dword s3, s[16:17], 0x300
    s_load_dword s3, s[16:17], 0x340
    s_load_dword s3, s[16:17], 0x380
    s_load_dword s3, s[16:17], 0x3c0
    s_load_dword s3, s[16:17], 0x400
    s_load_dword s3, s[16:17], 0x440
    s_load_dword s3, s[16:17], 0x480
    s_load_dword s3, s[16:17], 0x4c0
    s_load_dword s3, s[16:17], 0x500
    s_load_dword s3, s[16:17], 0x540
    s_load_dword s3, s[16:17], 0x580
    s_load_dword s3, s[16:17], 0x5c0
    s_load_dword s3, s[16:17], 0x600
    s_load_dword s3, s[16:17], 0x640
    s_load_dword s3, s[16:17], 0x680
    s_load_dword s3, s[16:17], 0x6c0
    s_load_dword s3, s[8:9], 0x0
    s_load_dword s3, s[8:9], 0x40
    s_load_dword s3, s[8:9], 0x80
    s_load_dword s3, s[8:9], 0xc0
    s_load_dword s3, s[8:9], 0x100
    s_load_dword s3, s[8:9], 0x140
    s_load_dword s3, s[8:9], 0x180
    s_load_dword s3, s[8:9], 0x1c0
    s_xor_b32 s15, s70, 4
    s_and_b32 s76, s71, 3
    s_add_u32 s76, s76, s72
    s_bitcmp1_b32 s15, 0
    s_cselect_b32 s77, 3, 0
    s_cselect_b32 s78, 0, 4
    s_cselect_b32 s11, 12, 3
    s_cselect_b32 s12, 3, 12
    s_add_u32 s4, s76, 0
    s_and_b32 s4, s4, 3
    s_add_u32 s4, s4, s77
    s_lshl_b32 s4, s4, 12
    s_add_u32 s5, s76, 1
    s_and_b32 s5, s5, 3
    s_add_u32 s5, s5, s77
    s_lshl_b32 s5, s5, 12
    s_add_u32 s6, s76, 2
    s_and_b32 s6, s6, 3
    s_add_u32 s6, s6, s77
    s_lshl_b32 s6, s6, 12
    s_add_u32 s7, s76, 3
    s_and_b32 s7, s7, 3
    s_add_u32 s7, s7, s77
    s_lshl_b32 s7, s7, 12
    s_lshl_b32 s76, s76, 1
    s_lshr_b32 s8, 0x924924, s76
    s_and_b32 s8, s8, 3
    s_add_u32 s8, s8, s78
    s_lshl_b32 s8, s8, 12
    s_lshr_b32 s9, 0x249249, s76
    s_and_b32 s9, s9, 3
    s_add_u32 s9, s9, s78
    s_lshl_b32 s9, s9, 12
    s_lshr_b32 s10, 0x492492, s76
    s_and_b32 s10, s10, 3
    s_add_u32 s10, s10, s78
    s_lshl_b32 s10, s10, 12
    s_lshl_b32 s76, s15, 2
    s_lshl_b32 s11, s11, s76
    s_lshl_b32 s12, s12, s76
    s_lshl_b32 s76, s15, 1
    s_lshl_b32 s13, 3, s76
    s_mul_i32 s89, s15, 229376
    s_mul_i32 s77, s71, 294912
    s_mul_i32 s90, s15, 28672
    s_add_u32 s90, s90, s77
    s_lshl_b32 s14, s15, 13
    s_add_u32 s14, s14, s77
    s_add_u32 s14, s14, 229376
    s_lshl_b32 s93, s71, 8
    s_add_u32 s93, s93, 0xa58000
    s_cmp_eq_u32 s73, 1
    s_cbranch_scc1 k_CB
    s_barrier
    ds_read_b64_tr_b16 v[64:65], v86 offset:0
    ds_read_b64_tr_b16 v[66:67], v86 offset:512
    ds_read_b128 v[32:35], v84 offset:0
    ds_read_b128 v[36:39], v84 offset:2048
    ds_read_b128 v[40:43], v84 offset:4096
    ds_read_b128 v[44:47], v84 offset:6144
    ds_read_b64_tr_b16 v[68:69], v86 offset:10240
    ds_read_b64_tr_b16 v[70:71], v86 offset:10752
    ds_read_b64_tr_b16 v[72:73], v87 offset:0
    ds_read_b64_tr_b16 v[74:75], v87 offset:512
.p2align 3
k_loop0:
    s_waitcnt lgkmcnt(8)
    s_waitcnt lgkmcnt(7)
    v_mfma_f32_16x16x32_bf16 v[96:99], v[64:67], v[32:35], v[96:99]
    ds_read_b64_tr_b16 v[76:77], v87 offset:10240
    s_waitcnt lgkmcnt(7)
    v_mfma_f32_16x16x32_bf16 v[100:103], v[64:67], v[36:39], v[100:103]
    ds_read_b64_tr_b16 v[78:79], v87 offset:10752
    s_waitcnt lgkmcnt(7)
    v_mfma_f32_16x16x32_bf16 v[104:107], v[64:67], v[40:43], v[104:107]
    s_waitcnt lgkmcnt(6)
    v_mfma_f32_16x16x32_bf16 v[108:111], v[64:67], v[44:47], v[108:111]
    s_add_u32 s82, s82, 1
    s_cmp_eq_u32 s82, 2
    s_waitcnt lgkmcnt(4)
    v_mfma_f32_16x16x32_bf16 v[112:115], v[68:71], v[32:35], v[112:115]
    ds_read_b64_tr_b16 v[80:81], v88 offset:0
    v_mfma_f32_16x16x32_bf16 v[116:119], v[68:71], v[36:39], v[116:119]
    ds_read_b64_tr_b16 v[82:83], v88 offset:512
    v_mfma_f32_16x16x32_bf16 v[120:123], v[68:71], v[40:43], v[120:123]
    s_mov_b32 s80, 53248
    s_cselect_b32 s80, 0xfffe6000, s80
    v_mfma_f32_16x16x32_bf16 v[124:127], v[68:71], v[44:47], v[124:127]
    s_cmp_eq_u32 s82, 3
    s_cselect_b32 s82, 0, s82
    s_waitcnt lgkmcnt(4)
    v_mfma_f32_16x16x32_bf16 v[128:131], v[72:75], v[32:35], v[128:131]
    ds_read_b64_tr_b16 v[64:65], v88 offset:10240
    v_mfma_f32_16x16x32_bf16 v[132:135], v[72:75], v[36:39], v[132:135]
    ds_read_b64_tr_b16 v[66:67], v88 offset:10752
    v_mfma_f32_16x16x32_bf16 v[136:139], v[72:75], v[40:43], v[136:139]
    ds_read_b128 v[48:51], v85 offset:0
    v_mfma_f32_16x16x32_bf16 v[140:143], v[72:75], v[44:47], v[140:143]
    s_waitcnt lgkmcnt(5)
    v_mfma_f32_16x16x32_bf16 v[144:147], v[76:79], v[32:35], v[144:147]
    ds_read_b64_tr_b16 v[68:69], v89 offset:0
    v_mfma_f32_16x16x32_bf16 v[148:151], v[76:79], v[36:39], v[148:151]
    ds_read_b64_tr_b16 v[70:71], v89 offset:512
    v_mfma_f32_16x16x32_bf16 v[152:155], v[76:79], v[40:43], v[152:155]
    ds_read_b128 v[52:55], v85 offset:2048
    v_mfma_f32_16x16x32_bf16 v[156:159], v[76:79], v[44:47], v[156:159]
    s_waitcnt lgkmcnt(6)
    v_mfma_f32_16x16x32_bf16 v[160:163], v[80:83], v[32:35], v[160:163]
    ds_read_b64_tr_b16 v[72:73], v89 offset:10240
    v_mfma_f32_16x16x32_bf16 v[164:167], v[80:83], v[36:39], v[164:167]
    ds_read_b64_tr_b16 v[74:75], v89 offset:10752
    v_mfma_f32_16x16x32_bf16 v[168:171], v[80:83], v[40:43], v[168:171]
    ds_read_b128 v[56:59], v85 offset:4096
    v_mfma_f32_16x16x32_bf16 v[172:175], v[80:83], v[44:47], v[172:175]
    s_waitcnt lgkmcnt(7)
    v_mfma_f32_16x16x32_bf16 v[176:179], v[64:67], v[32:35], v[176:179]
    ds_read_b64_tr_b16 v[76:77], v90 offset:0
    v_mfma_f32_16x16x32_bf16 v[180:183], v[64:67], v[36:39], v[180:183]
    ds_read_b64_tr_b16 v[78:79], v90 offset:256
    v_mfma_f32_16x16x32_bf16 v[184:187], v[64:67], v[40:43], v[184:187]
    ds_read_b128 v[60:63], v85 offset:6144
    v_mfma_f32_16x16x32_bf16 v[188:191], v[64:67], v[44:47], v[188:191]
    s_waitcnt lgkmcnt(7)
    v_mfma_f32_16x16x32_bf16 v[192:195], v[68:71], v[32:35], v[192:195]
    ds_read_b64_tr_b16 v[80:81], v91 offset:0
    v_mfma_f32_16x16x32_bf16 v[196:199], v[68:71], v[36:39], v[196:199]
    ds_read_b64_tr_b16 v[82:83], v91 offset:256
    v_mfma_f32_16x16x32_bf16 v[200:203], v[68:71], v[40:43], v[200:203]
    v_add_u32 v84, s80, v84
    v_mfma_f32_16x16x32_bf16 v[204:207], v[68:71], v[44:47], v[204:207]
    s_waitcnt lgkmcnt(6)
    v_mfma_f32_16x16x32_bf16 v[208:211], v[72:75], v[32:35], v[208:211]
    ds_read_b64_tr_b16 v[64:65], v86 offset:5120
    v_mfma_f32_16x16x32_bf16 v[212:215], v[72:75], v[36:39], v[212:215]
    ds_read_b64_tr_b16 v[66:67], v86 offset:5632
    v_mfma_f32_16x16x32_bf16 v[216:219], v[72:75], v[40:43], v[216:219]
    v_add_u32 v85, s80, v85
    v_mfma_f32_16x16x32_bf16 v[220:223], v[72:75], v[44:47], v[220:223]
    s_waitcnt lgkmcnt(5)
    v_mfma_f32_16x16x32_bf16 v[224:227], v[76:79], v[32:35], v[224:227]
    ds_read_b64_tr_b16 v[68:69], v86 offset:15360
    v_mfma_f32_16x16x32_bf16 v[228:231], v[76:79], v[36:39], v[228:231]
    ds_read_b64_tr_b16 v[70:71], v86 offset:15872
    v_mfma_f32_16x16x32_bf16 v[232:235], v[76:79], v[40:43], v[232:235]
    v_mfma_f32_16x16x32_bf16 v[236:239], v[76:79], v[44:47], v[236:239]
    s_waitcnt lgkmcnt(4)
    v_mfma_f32_16x16x32_bf16 v[240:243], v[80:83], v[32:35], v[240:243]
    ds_read_b64_tr_b16 v[72:73], v87 offset:5120
    v_mfma_f32_16x16x32_bf16 v[244:247], v[80:83], v[36:39], v[244:247]
    ds_read_b64_tr_b16 v[74:75], v87 offset:5632
    v_mfma_f32_16x16x32_bf16 v[248:251], v[80:83], v[40:43], v[248:251]
    v_add_u32 v86, s80, v86
    v_mfma_f32_16x16x32_bf16 v[252:255], v[80:83], v[44:47], v[252:255]
    s_waitcnt lgkmcnt(4)
    v_mfma_f32_16x16x32_bf16 v[96:99], v[64:67], v[48:51], v[96:99]
    ds_read_b64_tr_b16 v[76:77], v87 offset:15360
    v_mfma_f32_16x16x32_bf16 v[100:103], v[64:67], v[52:55], v[100:103]
    ds_read_b64_tr_b16 v[78:79], v87 offset:15872
    v_mfma_f32_16x16x32_bf16 v[104:107], v[64:67], v[56:59], v[104:107]
    v_mfma_f32_16x16x32_bf16 v[108:111], v[64:67], v[60:63], v[108:111]
    s_waitcnt lgkmcnt(4)
    v_mfma_f32_16x16x32_bf16 v[112:115], v[68:71], v[48:51], v[112:115]
    ds_read_b64_tr_b16 v[80:81], v88 offset:5120
    v_mfma_f32_16x16x32_bf16 v[116:119], v[68:71], v[52:55], v[116:119]
    ds_read_b64_tr_b16 v[82:83], v88 offset:5632
    v_mfma_f32_16x16x32_bf16 v[120:123], v[68:71], v[56:59], v[120:123]
    v_add_u32 v87, s80, v87
    v_mfma_f32_16x16x32_bf16 v[124:127], v[68:71], v[60:63], v[124:127]
    s_waitcnt lgkmcnt(4)
    v_mfma_f32_16x16x32_bf16 v[128:131], v[72:75], v[48:51], v[128:131]
    ds_read_b64_tr_b16 v[64:65], v88 offset:15360
    v_mfma_f32_16x16x32_bf16 v[132:135], v[72:75], v[52:55], v[132:135]
    ds_read_b64_tr_b16 v[66:67], v88 offset:15872
    v_mfma_f32_16x16x32_bf16 v[136:139], v[72:75], v[56:59], v[136:139]
    v_mfma_f32_16x16x32_bf16 v[140:143], v[72:75], v[60:63], v[140:143]
    s_waitcnt lgkmcnt(4)
    v_mfma_f32_16x16x32_bf16 v[144:147], v[76:79], v[48:51], v[144:147]
    ds_read_b64_tr_b16 v[68:69], v89 offset:5120
    v_mfma_f32_16x16x32_bf16 v[148:151], v[76:79], v[52:55], v[148:151]
    ds_read_b64_tr_b16 v[70:71], v89 offset:5632
    v_mfma_f32_16x16x32_bf16 v[152:155], v[76:79], v[56:59], v[152:155]
    v_add_u32 v88, s80, v88
    v_mfma_f32_16x16x32_bf16 v[156:159], v[76:79], v[60:63], v[156:159]
    s_waitcnt lgkmcnt(4)
    v_mfma_f32_16x16x32_bf16 v[160:163], v[80:83], v[48:51], v[160:163]
    ds_read_b64_tr_b16 v[72:73], v89 offset:15360
    v_mfma_f32_16x16x32_bf16 v[164:167], v[80:83], v[52:55], v[164:167]
    ds_read_b64_tr_b16 v[74:75], v89 offset:15872
    v_mfma_f32_16x16x32_bf16 v[168:171], v[80:83], v[56:59], v[168:171]
    v_add_u32 v89, s80, v89
    v_mfma_f32_16x16x32_bf16 v[172:175], v[80:83], v[60:63], v[172:175]
    s_waitcnt lgkmcnt(4)
    v_mfma_f32_16x16x32_bf16 v[176:179], v[64:67], v[48:51], v[176:179]
    ds_read_b64_tr_b16 v[76:77], v90 offset:10240
    v_mfma_f32_16x16x32_bf16 v[180:183], v[64:67], v[52:55], v[180:183]
    ds_read_b64_tr_b16 v[78:79], v90 offset:10496
    v_mfma_f32_16x16x32_bf16 v[184:187], v[64:67], v[56:59], v[184:187]
    v_add_u32 v90, s80, v90
    v_mfma_f32_16x16x32_bf16 v[188:191], v[64:67], v[60:63], v[188:191]
    s_waitcnt lgkmcnt(4)
    v_mfma_f32_16x16x32_bf16 v[192:195], v[68:71], v[48:51], v[192:195]
    ds_read_b64_tr_b16 v[80:81], v91 offset:10240
    v_mfma_f32_16x16x32_bf16 v[196:199], v[68:71], v[52:55], v[196:199]
    ds_read_b64_tr_b16 v[82:83], v91 offset:10496
    v_mfma_f32_16x16x32_bf16 v[200:203], v[68:71], v[56:59], v[200:203]
    v_add_u32 v91, s80, v91
    v_mfma_f32_16x16x32_bf16 v[204:207], v[68:71], v[60:63], v[204:207]
    s_waitcnt lgkmcnt(0)
    s_barrier
    v_mfma_f32_16x16x32_bf16 v[208:211], v[72:75], v[48:51], v[208:211]
    ds_read_b64_tr_b16 v[64:65], v86 offset:0
    ds_read_b64_tr_b16 v[66:67], v86 offset:512
    v_mfma_f32_16x16x32_bf16 v[212:215], v[72:75], v[52:55], v[212:215]
    ds_read_b128 v[32:35], v84 offset:0
    v_mfma_f32_16x16x32_bf16 v[216:219], v[72:75], v[56:59], v[216:219]
    ds_read_b128 v[36:39], v84 offset:2048
    v_mfma_f32_16x16x32_bf16 v[220:223], v[72:75], v[60:63], v[220:223]
    ds_read_b128 v[40:43], v84 offset:4096
    v_mfma_f32_16x16x32_bf16 v[224:227], v[76:79], v[48:51], v[224:227]
    ds_read_b128 v[44:47], v84 offset:6144
    v_mfma_f32_16x16x32_bf16 v[228:231], v[76:79], v[52:55], v[228:231]
    ds_read_b64_tr_b16 v[68:69], v86 offset:10240
    v_mfma_f32_16x16x32_bf16 v[232:235], v[76:79], v[56:59], v[232:235]
    ds_read_b64_tr_b16 v[70:71], v86 offset:10752
    v_mfma_f32_16x16x32_bf16 v[236:239], v[76:79], v[60:63], v[236:239]
    v_mfma_f32_16x16x32_bf16 v[240:243], v[80:83], v[48:51], v[240:243]
    ds_read_b64_tr_b16 v[72:73], v87 offset:0
    v_mfma_f32_16x16x32_bf16 v[244:247], v[80:83], v[52:55], v[244:247]
    ds_read_b64_tr_b16 v[74:75], v87 offset:512
    v_mfma_f32_16x16x32_bf16 v[248:251], v[80:83], v[56:59], v[248:251]
    s_add_u32 s81, s81, 1
    s_cmp_lt_u32 s81, 7
    v_mfma_f32_16x16x32_bf16 v[252:255], v[80:83], v[60:63], v[252:255]
    s_cbranch_scc1 k_loop0
    s_waitcnt lgkmcnt(8)
    s_waitcnt lgkmcnt(7)
    v_mfma_f32_16x16x32_bf16 v[96:99], v[64:67], v[32:35], v[96:99]
    ds_read_b64_tr_b16 v[76:77], v86 offset:5120
    s_waitcnt lgkmcnt(7)
    v_mfma_f32_16x16x32_bf16 v[100:103], v[64:67], v[36:39], v[100:103]
    ds_read_b64_tr_b16 v[78:79], v86 offset:5632
    s_waitcnt lgkmcnt(7)
    v_mfma_f32_16x16x32_bf16 v[104:107], v[64:67], v[40:43], v[104:107]
    ds_read_b128 v[48:51], v85 offset:0
    s_waitcnt lgkmcnt(7)
    v_mfma_f32_16x16x32_bf16 v[108:111], v[64:67], v[44:47], v[108:111]
    ds_read_b128 v[52:55], v85 offset:2048
    s_waitcnt lgkmcnt(6)
    v_mfma_f32_16x16x32_bf16 v[112:115], v[68:71], v[32:35], v[112:115]
    ds_read_b64_tr_b16 v[80:81], v86 offset:15360
    v_mfma_f32_16x16x32_bf16 v[116:119], v[68:71], v[36:39], v[116:119]
    ds_read_b64_tr_b16 v[82:83], v86 offset:15872
    v_mfma_f32_16x16x32_bf16 v[120:123], v[68:71], v[40:43], v[120:123]
    ds_read_b128 v[56:59], v85 offset:4096
    v_mfma_f32_16x16x32_bf16 v[124:127], v[68:71], v[44:47], v[124:127]
    ds_read_b128 v[60:63], v85 offset:6144
    s_waitcnt lgkmcnt(8)
    v_mfma_f32_16x16x32_bf16 v[128:131], v[72:75], v[32:35], v[128:131]
    ds_read_b64_tr_b16 v[64:65], v87 offset:10240
    v_mfma_f32_16x16x32_bf16 v[132:135], v[72:75], v[36:39], v[132:135]
    ds_read_b64_tr_b16 v[66:67], v87 offset:10752
    v_mfma_f32_16x16x32_bf16 v[136:139], v[72:75], v[40:43], v[136:139]
    ds_read_b128 v[6:9], v93
    v_mfma_f32_16x16x32_bf16 v[140:143], v[72:75], v[44:47], v[140:143]
    s_waitcnt lgkmcnt(9)
    s_waitcnt lgkmcnt(8)
    v_mfma_f32_16x16x32_bf16 v[96:99], v[76:79], v[48:51], v[96:99]
    ds_read_b64_tr_b16 v[68:69], v87 offset:5120
    s_waitcnt lgkmcnt(8)
    v_mfma_f32_16x16x32_bf16 v[100:103], v[76:79], v[52:55], v[100:103]
    ds_read_b64_tr_b16 v[70:71], v87 offset:5632
    s_waitcnt lgkmcnt(6)
    v_mfma_f32_16x16x32_bf16 v[104:107], v[76:79], v[56:59], v[104:107]
    s_waitcnt lgkmcnt(2)
    v_lshlrev_b32 v16, 16, v6
    v_lshlrev_b32 v17, 16, v7
    v_mfma_f32_16x16x32_bf16 v[108:111], v[76:79], v[60:63], v[108:111]
    v_lshlrev_b32 v18, 16, v8
    v_lshlrev_b32 v19, 16, v9
    v_mfma_f32_16x16x32_bf16 v[112:115], v[80:83], v[48:51], v[112:115]
    ds_read_b64_tr_b16 v[72:73], v87 offset:15360
    v_mfma_f32_16x16x32_bf16 v[116:119], v[80:83], v[52:55], v[116:119]
    ds_read_b64_tr_b16 v[74:75], v87 offset:15872
    v_mfma_f32_16x16x32_bf16 v[120:123], v[80:83], v[56:59], v[120:123]
    v_mfma_f32_16x16x32_bf16 v[124:127], v[80:83], v[60:63], v[124:127]
    v_mfma_f32_16x16x32_bf16 v[144:147], v[64:67], v[32:35], v[144:147]
    ds_read_b64_tr_b16 v[76:77], v88 offset:0
    s_nop 0
    v_mul_f32 v96, v96, v112
    v_mfma_f32_16x16x32_bf16 v[148:151], v[64:67], v[36:39], v[148:151]
    ds_read_b64_tr_b16 v[78:79], v88 offset:512
    v_mul_f32 v97, v97, v113
    v_mfma_f32_16x16x32_bf16 v[152:155], v[64:67], v[40:43], v[152:155]
    v_mul_f32 v98, v98, v114
    v_mul_f32 v99, v99, v115
    v_mfma_f32_16x16x32_bf16 v[156:159], v[64:67], v[44:47], v[156:159]
    v_mul_f32 v100, v100, v116
    v_mul_f32 v101, v101, v117
    s_waitcnt lgkmcnt(4)
    v_mfma_f32_16x16x32_bf16 v[128:131], v[68:71], v[48:51], v[128:131]
    ds_read_b64_tr_b16 v[80:81], v88 offset:10240
    v_mul_f32 v102, v102, v118
    v_mfma_f32_16x16x32_bf16 v[132:135], v[68:71], v[52:55], v[132:135]
    ds_read_b64_tr_b16 v[82:83], v88 offset:10752
    v_mul_f32 v103, v103, v119
    v_mfma_f32_16x16x32_bf16 v[136:139], v[68:71], v[56:59], v[136:139]
    v_mul_f32 v96, v96, v16
    v_mul_f32 v97, v97, v16
    v_mfma_f32_16x16x32_bf16 v[140:143], v[68:71], v[60:63], v[140:143]
    v_mul_f32 v98, v98, v16
    v_mul_f32 v99, v99, v16
    s_waitcnt lgkmcnt(4)
    v_mfma_f32_16x16x32_bf16 v[144:147], v[72:75], v[48:51], v[144:147]
    ds_read_b64_tr_b16 v[64:65], v88 offset:5120
    v_mul_f32 v100, v100, v17
    v_mfma_f32_16x16x32_bf16 v[148:151], v[72:75], v[52:55], v[148:151]
    ds_read_b64_tr_b16 v[66:67], v88 offset:5632
    v_mul_f32 v101, v101, v17
    v_mfma_f32_16x16x32_bf16 v[152:155], v[72:75], v[56:59], v[152:155]
    v_mul_f32 v102, v102, v17
    v_mul_f32 v103, v103, v17
    v_mfma_f32_16x16x32_bf16 v[156:159], v[72:75], v[60:63], v[156:159]
    v_cvt_pk_bf16_f32 v96, v96, v97
    v_cvt_pk_bf16_f32 v97, v98, v99
    s_waitcnt lgkmcnt(4)
    v_mfma_f32_16x16x32_bf16 v[160:163], v[76:79], v[32:35], v[160:163]
    ds_read_b64_tr_b16 v[68:69], v88 offset:15360
    v_cvt_pk_bf16_f32 v98, v100, v101
    v_mfma_f32_16x16x32_bf16 v[164:167], v[76:79], v[36:39], v[164:167]
    ds_read_b64_tr_b16 v[70:71], v88 offset:15872
    v_cvt_pk_bf16_f32 v99, v102, v103
    v_mfma_f32_16x16x32_bf16 v[168:171], v[76:79], v[40:43], v[168:171]
    buffer_store_dwordx4 v[96:99], v5, s[44:47], s83 offen offset:0 sc1
    v_mul_f32 v104, v104, v120
    v_mfma_f32_16x16x32_bf16 v[172:175], v[76:79], v[44:47], v[172:175]
    v_mul_f32 v105, v105, v121
    v_mul_f32 v106, v106, v122
    s_waitcnt lgkmcnt(4)
    v_mfma_f32_16x16x32_bf16 v[176:179], v[80:83], v[32:35], v[176:179]
    ds_read_b64_tr_b16 v[72:73], v89 offset:0
    v_mul_f32 v107, v107, v123
    v_mfma_f32_16x16x32_bf16 v[180:183], v[80:83], v[36:39], v[180:183]
    ds_read_b64_tr_b16 v[74:75], v89 offset:512
    v_mul_f32 v108, v108, v124
    v_mfma_f32_16x16x32_bf16 v[184:187], v[80:83], v[40:43], v[184:187]
    v_mul_f32 v109, v109, v125
    v_mul_f32 v110, v110, v126
    v_mfma_f32_16x16x32_bf16 v[188:191], v[80:83], v[44:47], v[188:191]
    v_mul_f32 v111, v111, v127
    v_mul_f32 v104, v104, v18
    s_waitcnt lgkmcnt(4)
    v_mfma_f32_16x16x32_bf16 v[160:163], v[64:67], v[48:51], v[160:163]
    ds_read_b64_tr_b16 v[76:77], v89 offset:10240
    v_mul_f32 v105, v105, v18
    v_mfma_f32_16x16x32_bf16 v[164:167], v[64:67], v[52:55], v[164:167]
    ds_read_b64_tr_b16 v[78:79], v89 offset:10752
    v_mul_f32 v106, v106, v18
    v_mfma_f32_16x16x32_bf16 v[168:171], v[64:67], v[56:59], v[168:171]
    v_mul_f32 v107, v107, v18
    v_mul_f32 v108, v108, v19
    v_mfma_f32_16x16x32_bf16 v[172:175], v[64:67], v[60:63], v[172:175]
    v_mul_f32 v109, v109, v19
    v_mul_f32 v110, v110, v19
    s_waitcnt lgkmcnt(4)
    v_mfma_f32_16x16x32_bf16 v[176:179], v[68:71], v[48:51], v[176:179]
    ds_read_b64_tr_b16 v[80:81], v89 offset:5120
    v_mul_f32 v111, v111, v19
    v_mfma_f32_16x16x32_bf16 v[180:183], v[68:71], v[52:55], v[180:183]
    ds_read_b64_tr_b16 v[82:83], v89 offset:5632
    v_cvt_pk_bf16_f32 v104, v104, v105
    v_mfma_f32_16x16x32_bf16 v[184:187], v[68:71], v[56:59], v[184:187]
    v_cvt_pk_bf16_f32 v105, v106, v107
    v_cvt_pk_bf16_f32 v106, v108, v109
    v_mfma_f32_16x16x32_bf16 v[188:191], v[68:71], v[60:63], v[188:191]
    v_cvt_pk_bf16_f32 v107, v110, v111
    buffer_store_dwordx4 v[104:107], v5, s[44:47], s83 offen offset:1024 sc1
    s_waitcnt lgkmcnt(4)
    v_mfma_f32_16x16x32_bf16 v[192:195], v[72:75], v[32:35], v[192:195]
    ds_read_b64_tr_b16 v[64:65], v89 offset:15360
    v_mul_f32 v128, v128, v144
    v_mfma_f32_16x16x32_bf16 v[196:199], v[72:75], v[36:39], v[196:199]
    ds_read_b64_tr_b16 v[66:67], v89 offset:15872
    v_mul_f32 v129, v129, v145
    v_mfma_f32_16x16x32_bf16 v[200:203], v[72:75], v[40:43], v[200:203]
    v_mul_f32 v130, v130, v146
    v_mul_f32 v131, v131, v147
    v_mfma_f32_16x16x32_bf16 v[204:207], v[72:75], v[44:47], v[204:207]
    v_mul_f32 v132, v132, v148
    v_mul_f32 v133, v133, v149
    s_waitcnt lgkmcnt(4)
    v_mfma_f32_16x16x32_bf16 v[208:211], v[76:79], v[32:35], v[208:211]
    ds_read_b64_tr_b16 v[68:69], v90 offset:0
    v_mul_f32 v134, v134, v150
    v_mfma_f32_16x16x32_bf16 v[212:215], v[76:79], v[36:39], v[212:215]
    ds_read_b64_tr_b16 v[70:71], v90 offset:256
    v_mul_f32 v135, v135, v151
    v_mfma_f32_16x16x32_bf16 v[216:219], v[76:79], v[40:43], v[216:219]
    v_mul_f32 v128, v128, v16
    v_mul_f32 v129, v129, v16
    v_mfma_f32_16x16x32_bf16 v[220:223], v[76:79], v[44:47], v[220:223]
    v_mul_f32 v130, v130, v16
    v_mul_f32 v131, v131, v16
    s_waitcnt lgkmcnt(4)
    v_mfma_f32_16x16x32_bf16 v[192:195], v[80:83], v[48:51], v[192:195]
    ds_read_b64_tr_b16 v[72:73], v91 offset:0
    v_mul_f32 v132, v132, v17
    v_mfma_f32_16x16x32_bf16 v[196:199], v[80:83], v[52:55], v[196:199]
    ds_read_b64_tr_b16 v[74:75], v91 offset:256
    v_mul_f32 v133, v133, v17
    v_mfma_f32_16x16x32_bf16 v[200:203], v[80:83], v[56:59], v[200:203]
    v_mul_f32 v134, v134, v17
    v_mul_f32 v135, v135, v17
    v_mfma_f32_16x16x32_bf16 v[204:207], v[80:83], v[60:63], v[204:207]
    v_cvt_pk_bf16_f32 v128, v128, v129
    v_cvt_pk_bf16_f32 v129, v130, v131
    s_waitcnt lgkmcnt(4)
    v_mfma_f32_16x16x32_bf16 v[208:211], v[64:67], v[48:51], v[208:211]
    ds_read_b64_tr_b16 v[76:77], v90 offset:10240
    v_cvt_pk_bf16_f32 v130, v132, v133
    v_mfma_f32_16x16x32_bf16 v[212:215], v[64:67], v[52:55], v[212:215]
    ds_read_b64_tr_b16 v[78:79], v90 offset:10496
    v_cvt_pk_bf16_f32 v131, v134, v135
    v_mfma_f32_16x16x32_bf16 v[216:219], v[64:67], v[56:59], v[216:219]
    buffer_store_dwordx4 v[128:131], v5, s[44:47], s83 offen offset:2048 sc1
    v_mul_f32 v136, v136, v152
    v_mfma_f32_16x16x32_bf16 v[220:223], v[64:67], v[60:63], v[220:223]
    v_mul_f32 v137, v137, v153
    v_mul_f32 v138, v138, v154
    s_waitcnt lgkmcnt(4)
    v_mfma_f32_16x16x32_bf16 v[224:227], v[68:71], v[32:35], v[224:227]
    ds_read_b64_tr_b16 v[80:81], v91 offset:10240
    v_mul_f32 v139, v139, v155
    v_mfma_f32_16x16x32_bf16 v[228:231], v[68:71], v[36:39], v[228:231]
    ds_read_b64_tr_b16 v[82:83], v91 offset:10496
    v_mul_f32 v140, v140, v156
    v_mfma_f32_16x16x32_bf16 v[232:235], v[68:71], v[40:43], v[232:235]
    v_mul_f32 v141, v141, v157
    v_mul_f32 v142, v142, v158
    v_mfma_f32_16x16x32_bf16 v[236:239], v[68:71], v[44:47], v[236:239]
    s_waitcnt lgkmcnt(0)
    s_barrier
    v_mul_f32 v143, v143, v159
    v_mul_f32 v136, v136, v18
    v_mfma_f32_16x16x32_bf16 v[240:243], v[72:75], v[32:35], v[240:243]
    v_mul_f32 v137, v137, v18
    v_mul_f32 v138, v138, v18
    v_mfma_f32_16x16x32_bf16 v[244:247], v[72:75], v[36:39], v[244:247]
    v_mul_f32 v139, v139, v18
    v_mul_f32 v140, v140, v19
    v_mfma_f32_16x16x32_bf16 v[248:251], v[72:75], v[40:43], v[248:251]
    v_mul_f32 v141, v141, v19
    v_mul_f32 v142, v142, v19
    v_mfma_f32_16x16x32_bf16 v[252:255], v[72:75], v[44:47], v[252:255]
    v_mul_f32 v143, v143, v19
    v_cvt_pk_bf16_f32 v136, v136, v137
    v_mfma_f32_16x16x32_bf16 v[224:227], v[76:79], v[48:51], v[224:227]
    v_cvt_pk_bf16_f32 v137, v138, v139
    v_cvt_pk_bf16_f32 v138, v140, v141
    v_mfma_f32_16x16x32_bf16 v[228:231], v[76:79], v[52:55], v[228:231]
    v_cvt_pk_bf16_f32 v139, v142, v143
    buffer_store_dwordx4 v[136:139], v5, s[44:47], s83 offen offset:3072 sc1
    v_mfma_f32_16x16x32_bf16 v[232:235], v[76:79], v[56:59], v[232:235]
    v_mul_f32 v160, v160, v176
    v_mul_f32 v161, v161, v177
    v_mfma_f32_16x16x32_bf16 v[236:239], v[76:79], v[60:63], v[236:239]
    v_mul_f32 v162, v162, v178
    v_mul_f32 v163, v163, v179
    v_mfma_f32_16x16x32_bf16 v[240:243], v[80:83], v[48:51], v[240:243]
    v_mul_f32 v164, v164, v180
    v_mul_f32 v165, v165, v181
    v_mfma_f32_16x16x32_bf16 v[244:247], v[80:83], v[52:55], v[244:247]
    v_mul_f32 v166, v166, v182
    v_mul_f32 v167, v167, v183
    v_mfma_f32_16x16x32_bf16 v[248:251], v[80:83], v[56:59], v[248:251]
    v_mul_f32 v160, v160, v16
    v_mul_f32 v161, v161, v16
    v_mfma_f32_16x16x32_bf16 v[252:255], v[80:83], v[60:63], v[252:255]
    v_mul_f32 v162, v162, v16
    v_mul_f32 v163, v163, v16
    v_mul_f32 v164, v164, v17
    v_mul_f32 v165, v165, v17
    v_mul_f32 v166, v166, v17
    v_mul_f32 v167, v167, v17
    v_cvt_pk_bf16_f32 v160, v160, v161
    v_cvt_pk_bf16_f32 v161, v162, v163
    v_cvt_pk_bf16_f32 v162, v164, v165
    v_cvt_pk_bf16_f32 v163, v166, v167
    buffer_store_dwordx4 v[160:163], v5, s[44:47], s33 offen offset:0 sc1
    v_mul_f32 v168, v168, v184
    v_mul_f32 v169, v169, v185
    v_mul_f32 v170, v170, v186
    v_mul_f32 v171, v171, v187
    v_mul_f32 v172, v172, v188
    v_mul_f32 v173, v173, v189
    v_mul_f32 v174, v174, v190
    v_mul_f32 v175, v175, v191
    v_mul_f32 v168, v168, v18
    v_mul_f32 v169, v169, v18
    v_mul_f32 v170, v170, v18
    v_mul_f32 v171, v171, v18
    v_mul_f32 v172, v172, v19
    v_mul_f32 v173, v173, v19
    v_mul_f32 v174, v174, v19
    v_mul_f32 v175, v175, v19
    v_cvt_pk_bf16_f32 v168, v168, v169
    v_cvt_pk_bf16_f32 v169, v170, v171
    v_cvt_pk_bf16_f32 v170, v172, v173
    v_cvt_pk_bf16_f32 v171, v174, v175
    buffer_store_dwordx4 v[168:171], v5, s[44:47], s33 offen offset:1024 sc1
    v_pk_mul_f32 v[192:193], v[192:193], v[208:209]
    v_pk_mul_f32 v[194:195], v[194:195], v[210:211]
    v_pk_mul_f32 v[196:197], v[196:197], v[212:213]
    v_pk_mul_f32 v[198:199], v[198:199], v[214:215]
    v_pk_mul_f32 v[192:193], v[192:193], v[16:17] op_sel_hi:[1,0]
    v_pk_mul_f32 v[194:195], v[194:195], v[16:17] op_sel_hi:[1,0]
    v_mul_f32 v196, v196, v17
    v_mul_f32 v197, v197, v17
    v_mul_f32 v198, v198, v17
    v_mul_f32 v199, v199, v17
    v_cvt_pk_bf16_f32 v192, v192, v193
    v_cvt_pk_bf16_f32 v193, v194, v195
    v_cvt_pk_bf16_f32 v194, v196, v197
    v_cvt_pk_bf16_f32 v195, v198, v199
    buffer_store_dwordx4 v[192:195], v5, s[44:47], s33 offen offset:2048 sc1
    v_pk_mul_f32 v[200:201], v[200:201], v[216:217]
    v_pk_mul_f32 v[202:203], v[202:203], v[218:219]
    v_pk_mul_f32 v[204:205], v[204:205], v[220:221]
    v_pk_mul_f32 v[206:207], v[206:207], v[222:223]
    v_pk_mul_f32 v[200:201], v[200:201], v[18:19] op_sel_hi:[1,0]
    v_pk_mul_f32 v[202:203], v[202:203], v[18:19] op_sel_hi:[1,0]
    v_mul_f32 v204, v204, v19
    v_mul_f32 v205, v205, v19
    v_mul_f32 v206, v206, v19
    v_mul_f32 v207, v207, v19
    v_cvt_pk_bf16_f32 v200, v200, v201
    v_cvt_pk_bf16_f32 v201, v202, v203
    v_cvt_pk_bf16_f32 v202, v204, v205
    v_cvt_pk_bf16_f32 v203, v206, v207
    buffer_store_dwordx4 v[200:203], v5, s[44:47], s33 offen offset:3072 sc1
    s_barrier
    s_setprio 3
    v_and_b32 v92, 0xffff0000, v6
    v_and_b32 v93, 0xffff0000, v7
    v_and_b32 v94, 0xffff0000, v8
    v_and_b32 v95, 0xffff0000, v9
    v_lshrrev_b32 v6, 3, v1
    s_lshl_b32 s76, s72, 7
    v_lshl_add_u32 v6, v6, 10, s76
    v_bfe_u32 v7, v1, 1, 2
    v_xor_b32 v7, v7, v3
    v_lshl_add_u32 v6, v7, 5, v6
    v_and_b32 v7, 1, v1
    v_lshl_add_u32 v84, v7, 4, v6
    v_add_u32 v85, 7168, v84
    v_add_u32 v86, 14336, v84
    v_add_u32 v87, 21504, v84
    v_lshrrev_b32 v6, 2, v1
    v_lshl_add_u32 v6, v6, 7, s92
    v_and_b32 v7, 3, v1
    v_lshl_add_u32 v6, v7, 3, v6
    v_bfe_u32 v7, v1, 3, 2
    v_lshl_add_u32 v88, v7, 5, v6
    v_xor_b32 v89, 32, v88
    v_xor_b32 v90, 64, v88
    v_xor_b32 v91, 96, v88
    s_add_u32 m0, s92, 0
    s_lshl3_add_u32 s88, s4, s89
    buffer_load_dwordx4 v84, s[56:59], s88 offen offset:0 lds
    buffer_load_dwordx4 v85, s[56:59], s88 offen offset:1024 lds
    buffer_load_dwordx4 v86, s[56:59], s88 offen offset:2048 lds
    buffer_load_dwordx4 v87, s[56:59], s88 offen offset:3072 lds
    s_add_u32 m0, s92, 4096
    s_lshl3_add_u32 s88, s5, s89
    buffer_load_dwordx4 v84, s[56:59], s88 offen offset:0 lds
    buffer_load_dwordx4 v85, s[56:59], s88 offen offset:1024 lds
    buffer_load_dwordx4 v86, s[56:59], s88 offen offset:2048 lds
    buffer_load_dwordx4 v87, s[56:59], s88 offen offset:3072 lds
    s_add_u32 m0, s92, 8192
    s_lshl3_add_u32 s88, s6, s89
    buffer_load_dwordx4 v84, s[56:59], s88 offen offset:0 lds
    buffer_load_dwordx4 v85, s[56:59], s88 offen offset:1024 lds
    buffer_load_dwordx4 v86, s[56:59], s88 offen offset:2048 lds
    buffer_load_dwordx4 v87, s[56:59], s88 offen offset:3072 lds
    s_add_u32 m0, s92, 12288
    s_lshl3_add_u32 s88, s7, s89
    buffer_load_dwordx4 v84, s[56:59], s88 offen offset:0 lds
    buffer_load_dwordx4 v85, s[56:59], s88 offen offset:1024 lds
    buffer_load_dwordx4 v86, s[56:59], s88 offen offset:2048 lds
    buffer_load_dwordx4 v87, s[56:59], s88 offen offset:3072 lds
    v_pk_fma_f32 v[32:33], v[224:225], s[84:85], s[84:85] neg_lo:[0,0,1] neg_hi:[0,0,1]
    v_pk_fma_f32 v[34:35], v[226:227], s[84:85], s[84:85] neg_lo:[0,0,1] neg_hi:[0,0,1]
    v_pk_fma_f32 v[36:37], v[228:229], s[84:85], s[84:85] neg_lo:[0,0,1] neg_hi:[0,0,1]
    v_pk_fma_f32 v[38:39], v[230:231], s[84:85], s[84:85] neg_lo:[0,0,1] neg_hi:[0,0,1]
    v_pk_fma_f32 v[40:41], v[232:233], s[84:85], s[84:85] neg_lo:[0,0,1] neg_hi:[0,0,1]
    v_pk_fma_f32 v[42:43], v[234:235], s[84:85], s[84:85] neg_lo:[0,0,1] neg_hi:[0,0,1]
    v_pk_fma_f32 v[44:45], v[236:237], s[84:85], s[84:85] neg_lo:[0,0,1] neg_hi:[0,0,1]
    v_pk_fma_f32 v[46:47], v[238:239], s[84:85], s[84:85] neg_lo:[0,0,1] neg_hi:[0,0,1]
    v_exp_f32_e64 v32, v32 clamp
    v_exp_f32_e64 v33, v33 clamp
    v_exp_f32_e64 v34, v34 clamp
    v_exp_f32_e64 v35, v35 clamp
    v_exp_f32_e64 v36, v36 clamp
    v_exp_f32_e64 v37, v37 clamp
    v_exp_f32_e64 v38, v38 clamp
    v_exp_f32_e64 v39, v39 clamp
    v_exp_f32_e64 v40, v40 clamp
    v_exp_f32_e64 v41, v41 clamp
    v_exp_f32_e64 v42, v42 clamp
    v_exp_f32_e64 v43, v43 clamp
    v_exp_f32_e64 v44, v44 clamp
    v_exp_f32_e64 v45, v45 clamp
    v_exp_f32_e64 v46, v46 clamp
    v_exp_f32_e64 v47, v47 clamp
    v_max_f32 v32, v32, v224
    v_max_f32 v33, v33, v225
    v_max_f32 v34, v34, v226
    v_max_f32 v35, v35, v227
    v_max_f32 v36, v36, v228
    v_max_f32 v37, v37, v229
    v_max_f32 v38, v38, v230
    v_max_f32 v39, v39, v231
    v_max_f32 v40, v40, v232
    v_max_f32 v41, v41, v233
    v_max_f32 v42, v42, v234
    v_max_f32 v43, v43, v235
    v_max_f32 v44, v44, v236
    v_max_f32 v45, v45, v237
    v_max_f32 v46, v46, v238
    v_max_f32 v47, v47, v239
    v_pk_add_f32 v[32:33], v[32:33], s[86:87]
    v_pk_add_f32 v[34:35], v[34:35], s[86:87]
    v_pk_add_f32 v[36:37], v[36:37], s[86:87]
    v_pk_add_f32 v[38:39], v[38:39], s[86:87]
    v_pk_add_f32 v[40:41], v[40:41], s[86:87]
    v_pk_add_f32 v[42:43], v[42:43], s[86:87]
    v_pk_add_f32 v[44:45], v[44:45], s[86:87]
    v_pk_add_f32 v[46:47], v[46:47], s[86:87]
    v_cvt_pk_bf16_f32 v16, v32, v33
    v_cvt_pk_bf16_f32 v17, v34, v35
    v_cvt_pk_bf16_f32 v20, v36, v37
    v_cvt_pk_bf16_f32 v21, v38, v39
    v_cvt_pk_bf16_f32 v24, v40, v41
    v_cvt_pk_bf16_f32 v25, v42, v43
    v_cvt_pk_bf16_f32 v28, v44, v45
    v_cvt_pk_bf16_f32 v29, v46, v47
    v_pk_fma_f32 v[32:33], v[240:241], s[84:85], s[84:85] neg_lo:[0,0,1] neg_hi:[0,0,1]
    v_pk_fma_f32 v[34:35], v[242:243], s[84:85], s[84:85] neg_lo:[0,0,1] neg_hi:[0,0,1]
    v_pk_fma_f32 v[36:37], v[244:245], s[84:85], s[84:85] neg_lo:[0,0,1] neg_hi:[0,0,1]
    v_pk_fma_f32 v[38:39], v[246:247], s[84:85], s[84:85] neg_lo:[0,0,1] neg_hi:[0,0,1]
    v_pk_fma_f32 v[40:41], v[248:249], s[84:85], s[84:85] neg_lo:[0,0,1] neg_hi:[0,0,1]
    v_pk_fma_f32 v[42:43], v[250:251], s[84:85], s[84:85] neg_lo:[0,0,1] neg_hi:[0,0,1]
    v_pk_fma_f32 v[44:45], v[252:253], s[84:85], s[84:85] neg_lo:[0,0,1] neg_hi:[0,0,1]
    v_pk_fma_f32 v[46:47], v[254:255], s[84:85], s[84:85] neg_lo:[0,0,1] neg_hi:[0,0,1]
    v_exp_f32_e64 v32, v32 clamp
    v_exp_f32_e64 v33, v33 clamp
    v_exp_f32_e64 v34, v34 clamp
    v_exp_f32_e64 v35, v35 clamp
    v_exp_f32_e64 v36, v36 clamp
    v_exp_f32_e64 v37, v37 clamp
    v_exp_f32_e64 v38, v38 clamp
    v_exp_f32_e64 v39, v39 clamp
    v_exp_f32_e64 v40, v40 clamp
    v_exp_f32_e64 v41, v41 clamp
    v_exp_f32_e64 v42, v42 clamp
    v_exp_f32_e64 v43, v43 clamp
    v_exp_f32_e64 v44, v44 clamp
    v_exp_f32_e64 v45, v45 clamp
    v_exp_f32_e64 v46, v46 clamp
    v_exp_f32_e64 v47, v47 clamp
    v_max_f32 v32, v32, v240
    v_max_f32 v33, v33, v241
    v_max_f32 v34, v34, v242
    v_max_f32 v35, v35, v243
    v_max_f32 v36, v36, v244
    v_max_f32 v37, v37, v245
    v_max_f32 v38, v38, v246
    v_max_f32 v39, v39, v247
    v_max_f32 v40, v40, v248
    v_max_f32 v41, v41, v249
    v_max_f32 v42, v42, v250
    v_max_f32 v43, v43, v251
    v_max_f32 v44, v44, v252
    v_max_f32 v45, v45, v253
    v_max_f32 v46, v46, v254
    v_max_f32 v47, v47, v255
    v_pk_add_f32 v[32:33], v[32:33], s[86:87]
    v_pk_add_f32 v[34:35], v[34:35], s[86:87]
    v_pk_add_f32 v[36:37], v[36:37], s[86:87]
    v_pk_add_f32 v[38:39], v[38:39], s[86:87]
    v_pk_add_f32 v[40:41], v[40:41], s[86:87]
    v_pk_add_f32 v[42:43], v[42:43], s[86:87]
    v_pk_add_f32 v[44:45], v[44:45], s[86:87]
    v_pk_add_f32 v[46:47], v[46:47], s[86:87]
    v_cvt_pk_bf16_f32 v18, v32, v33
    v_cvt_pk_bf16_f32 v19, v34, v35
    v_cvt_pk_bf16_f32 v22, v36, v37
    v_cvt_pk_bf16_f32 v23, v38, v39
    v_cvt_pk_bf16_f32 v26, v40, v41
    v_cvt_pk_bf16_f32 v27, v42, v43
    v_cvt_pk_bf16_f32 v30, v44, v45
    v_cvt_pk_bf16_f32 v31, v46, v47
    v_mov_b32 v0, 1
    s_waitcnt vmcnt(16)
    s_mov_b64 exec, 1
    buffer_store_dword v0, off, s[44:47], s34 sc1
    s_mov_b64 exec, -1
    s_setprio 0
    s_waitcnt vmcnt(13)
    ds_read_b64_tr_b16 v[96:97], v88 offset:0
    ds_read_b64_tr_b16 v[98:99], v88 offset:2048
    ds_read_b64_tr_b16 v[100:101], v89 offset:0
    ds_read_b64_tr_b16 v[102:103], v89 offset:2048
    ds_read_b64_tr_b16 v[104:105], v90 offset:0
    ds_read_b64_tr_b16 v[106:107], v90 offset:2048
    ds_read_b64_tr_b16 v[108:109], v91 offset:0
    ds_read_b64_tr_b16 v[110:111], v91 offset:2048
    s_waitcnt vmcnt(9)
    ds_read_b64_tr_b16 v[112:113], v88 offset:4096
    ds_read_b64_tr_b16 v[114:115], v88 offset:6144
    ds_read_b64_tr_b16 v[116:117], v89 offset:4096
    ds_read_b64_tr_b16 v[118:119], v89 offset:6144
    ds_read_b64_tr_b16 v[120:121], v90 offset:4096
    ds_read_b64_tr_b16 v[122:123], v90 offset:6144
    ds_read_b64_tr_b16 v[124:125], v91 offset:4096
    ds_read_b64_tr_b16 v[126:127], v91 offset:6144
    s_waitcnt vmcnt(5)
    ds_read_b64_tr_b16 v[128:129], v88 offset:8192
    ds_read_b64_tr_b16 v[130:131], v88 offset:10240
    ds_read_b64_tr_b16 v[132:133], v89 offset:8192
    ds_read_b64_tr_b16 v[134:135], v89 offset:10240
    ds_read_b64_tr_b16 v[136:137], v90 offset:8192
    ds_read_b64_tr_b16 v[138:139], v90 offset:10240
    ds_read_b64_tr_b16 v[140:141], v91 offset:8192
    ds_read_b64_tr_b16 v[142:143], v91 offset:10240
    buffer_load_dword v9, v2, s[44:47], s93 offen sc1
    s_waitcnt vmcnt(2)
    ds_read_b64_tr_b16 v[144:145], v88 offset:12288
    ds_read_b64_tr_b16 v[146:147], v88 offset:14336
    ds_read_b64_tr_b16 v[148:149], v89 offset:12288
    ds_read_b64_tr_b16 v[150:151], v89 offset:14336
    ds_read_b64_tr_b16 v[152:153], v90 offset:12288
    ds_read_b64_tr_b16 v[154:155], v90 offset:14336
    ds_read_b64_tr_b16 v[156:157], v91 offset:12288
    ds_read_b64_tr_b16 v[158:159], v91 offset:14336
    s_waitcnt vmcnt(0)
    v_cmp_eq_u32 s[94:95], 1, v9
    s_and_b32 s77, s94, s11
    s_cmp_eq_u32 s77, s11
    s_cbranch_scc0 k_f4
k_f4_ok:
    s_setprio 0
    s_add_u32 s91, s90, s4
    buffer_load_dwordx4 v[160:163], v5, s[44:47], s91 offen offset:0 sc1
    buffer_load_dwordx4 v[164:167], v5, s[44:47], s91 offen offset:1024 sc1
    buffer_load_dwordx4 v[168:171], v5, s[44:47], s91 offen offset:2048 sc1
    buffer_load_dwordx4 v[172:175], v5, s[44:47], s91 offen offset:3072 sc1
    s_setprio 1
    s_add_u32 s91, s90, s5
    buffer_load_dwordx4 v[176:179], v5, s[44:47], s91 offen offset:0 sc1
    buffer_load_dwordx4 v[180:183], v5, s[44:47], s91 offen offset:1024 sc1
    buffer_load_dwordx4 v[184:187], v5, s[44:47], s91 offen offset:2048 sc1
    buffer_load_dwordx4 v[188:191], v5, s[44:47], s91 offen offset:3072 sc1
    s_setprio 3
    s_add_u32 s91, s90, s6
    buffer_load_dwordx4 v[48:51], v5, s[44:47], s91 offen offset:0 sc1
    buffer_load_dwordx4 v[52:55], v5, s[44:47], s91 offen offset:1024 sc1
    buffer_load_dwordx4 v[56:59], v5, s[44:47], s91 offen offset:2048 sc1
    buffer_load_dwordx4 v[60:63], v5, s[44:47], s91 offen offset:3072 sc1
    s_lshl_b32 s76, s27, 12
    s_add_u32 s76, s76, 98304
    s_mul_i32 s92, s27, 12288
    v_mul_u32_u24 v6, 12288, v3
    v_lshl_add_u32 v7, v4, 4, v6
    v_and_b32 v8, 32, v5
    v_cmp_ne_u32 vcc, 0, v8
    v_lshrrev_b32 v8, 1, v8
    v_add_u32 v6, v6, v8
    s_waitcnt lgkmcnt(0)
    v_subrev_u32 v88, s76, v88
    v_subrev_u32 v89, s76, v89
    v_subrev_u32 v90, s76, v90
    v_subrev_u32 v91, s76, v91
    s_barrier
    buffer_load_dword v9, v2, s[44:47], s93 offen sc1
    ds_read_b128 v[40:43], v6 offset:57856
    ds_read_b128 v[32:35], v7 offset:57344
    ds_read_b128 v[36:39], v7 offset:57600
    s_waitcnt lgkmcnt(2)
    v_cvt_pk_bf16_f32 v40, v40, v41
    v_cvt_pk_bf16_f32 v41, v42, v43
    v_cndmask_b32 v44, v40, 0, vcc
    v_cndmask_b32 v46, 0, v40, vcc
    v_cndmask_b32 v45, v41, 0, vcc
    v_cndmask_b32 v47, 0, v41, vcc
    s_waitcnt lgkmcnt(0)
    v_cvt_pk_bf16_f32 v32, v32, v33
    v_cvt_pk_bf16_f32 v33, v34, v35
    v_cvt_pk_bf16_f32 v34, v36, v37
    v_cvt_pk_bf16_f32 v35, v38, v39
    v_mfma_f32_16x16x32_bf16 v[224:227], v[44:47], v[16:19], 0
    v_mfma_f32_16x16x32_bf16 v[228:231], v[44:47], v[20:23], 0
    v_mfma_f32_16x16x32_bf16 v[232:235], v[44:47], v[24:27], 0
    v_mfma_f32_16x16x32_bf16 v[236:239], v[44:47], v[28:31], 0
    v_mfma_f32_16x16x16_bf16 v[192:195], v[32:33], v[16:17], 0
    s_nop 3
    v_add_f32 v224, s86, v224
    v_rcp_f32 v224, v224
    v_mfma_f32_16x16x16_bf16 v[196:199], v[32:33], v[20:21], 0
    v_add_f32 v226, s86, v226
    v_rcp_f32 v226, v226
    v_mfma_f32_16x16x16_bf16 v[200:203], v[32:33], v[24:25], 0
    v_add_f32 v228, s86, v228
    v_rcp_f32 v228, v228
    v_mfma_f32_16x16x16_bf16 v[204:207], v[32:33], v[28:29], 0
    v_add_f32 v230, s86, v230
    v_rcp_f32 v230, v230
    v_mfma_f32_16x16x16_bf16 v[208:211], v[34:35], v[18:19], 0
    v_add_f32 v232, s86, v232
    v_rcp_f32 v232, v232
    v_mfma_f32_16x16x16_bf16 v[212:215], v[34:35], v[22:23], 0
    v_add_f32 v234, s86, v234
    v_rcp_f32 v234, v234
    v_mfma_f32_16x16x16_bf16 v[216:219], v[34:35], v[26:27], 0
    v_add_f32 v236, s86, v236
    v_rcp_f32 v236, v236
    v_mfma_f32_16x16x16_bf16 v[220:223], v[34:35], v[30:31], 0
    v_add_f32 v238, s86, v238
    v_rcp_f32 v238, v238
    v_mul_f32 v224, v224, v92
    v_mul_f32 v226, v226, v92
    v_mul_f32 v228, v228, v93
    v_mul_f32 v230, v230, v93
    v_mul_f32 v232, v232, v94
    v_mul_f32 v234, v234, v94
    v_mul_f32 v236, v236, v95
    v_mul_f32 v238, v238, v95
    v_pk_mul_f32 v[192:193], v[192:193], v[224:225] op_sel_hi:[1,0]
    v_pk_mul_f32 v[194:195], v[194:195], v[224:225] op_sel_hi:[1,0]
    v_pk_mul_f32 v[196:197], v[196:197], v[228:229] op_sel_hi:[1,0]
    v_pk_mul_f32 v[198:199], v[198:199], v[228:229] op_sel_hi:[1,0]
    v_cvt_pk_bf16_f32 v192, v192, v193
    v_cvt_pk_bf16_f32 v193, v194, v195
    v_cvt_pk_bf16_f32 v194, v196, v197
    v_cvt_pk_bf16_f32 v195, v198, v199
    buffer_store_dwordx4 v[192:195], v5, s[44:47], s32 offen offset:0 sc1
    v_pk_mul_f32 v[200:201], v[200:201], v[232:233] op_sel_hi:[1,0]
    v_pk_mul_f32 v[202:203], v[202:203], v[232:233] op_sel_hi:[1,0]
    v_pk_mul_f32 v[204:205], v[204:205], v[236:237] op_sel_hi:[1,0]
    v_pk_mul_f32 v[206:207], v[206:207], v[236:237] op_sel_hi:[1,0]
    v_cvt_pk_bf16_f32 v200, v200, v201
    v_cvt_pk_bf16_f32 v201, v202, v203
    v_cvt_pk_bf16_f32 v202, v204, v205
    v_cvt_pk_bf16_f32 v203, v206, v207
    buffer_store_dwordx4 v[200:203], v5, s[44:47], s32 offen offset:1024 sc1
    v_pk_mul_f32 v[208:209], v[208:209], v[226:227] op_sel_hi:[1,0]
    v_pk_mul_f32 v[210:211], v[210:211], v[226:227] op_sel_hi:[1,0]
    v_pk_mul_f32 v[212:213], v[212:213], v[230:231] op_sel_hi:[1,0]
    v_pk_mul_f32 v[214:215], v[214:215], v[230:231] op_sel_hi:[1,0]
    v_cvt_pk_bf16_f32 v208, v208, v209
    v_cvt_pk_bf16_f32 v209, v210, v211
    v_cvt_pk_bf16_f32 v210, v212, v213
    v_cvt_pk_bf16_f32 v211, v214, v215
    buffer_store_dwordx4 v[208:211], v5, s[44:47], s32 offen offset:2048 sc1
    v_pk_mul_f32 v[216:217], v[216:217], v[234:235] op_sel_hi:[1,0]
    v_pk_mul_f32 v[218:219], v[218:219], v[234:235] op_sel_hi:[1,0]
    v_pk_mul_f32 v[220:221], v[220:221], v[238:239] op_sel_hi:[1,0]
    v_pk_mul_f32 v[222:223], v[222:223], v[238:239] op_sel_hi:[1,0]
    v_cvt_pk_bf16_f32 v216, v216, v217
    v_cvt_pk_bf16_f32 v217, v218, v219
    v_cvt_pk_bf16_f32 v218, v220, v221
    v_cvt_pk_bf16_f32 v219, v222, v223
    buffer_store_dwordx4 v[216:219], v5, s[44:47], s32 offen offset:3072 sc1
    s_branch k_p2
k_CB:
    s_barrier
    ds_read_b64_tr_b16 v[64:65], v86 offset:0
    ds_read_b64_tr_b16 v[66:67], v86 offset:512
    ds_read_b128 v[32:35], v84 offset:0
    ds_read_b128 v[36:39], v84 offset:2048
    ds_read_b128 v[40:43], v84 offset:4096
    ds_read_b128 v[44:47], v84 offset:6144
    ds_read_b64_tr_b16 v[68:69], v87 offset:0
    ds_read_b64_tr_b16 v[70:71], v87 offset:512
    ds_read_b64_tr_b16 v[72:73], v88 offset:0
    ds_read_b64_tr_b16 v[74:75], v88 offset:512
.p2align 3
k_loop1:
    s_waitcnt lgkmcnt(8)
    s_waitcnt lgkmcnt(7)
    v_mfma_f32_16x16x32_bf16 v[96:99], v[32:35], v[64:67], v[96:99]
    ds_read_b64_tr_b16 v[76:77], v89 offset:0
    s_waitcnt lgkmcnt(7)
    v_mfma_f32_16x16x32_bf16 v[100:103], v[36:39], v[64:67], v[100:103]
    ds_read_b64_tr_b16 v[78:79], v89 offset:512
    s_waitcnt lgkmcnt(7)
    v_mfma_f32_16x16x32_bf16 v[104:107], v[40:43], v[64:67], v[104:107]
    s_waitcnt lgkmcnt(6)
    v_mfma_f32_16x16x32_bf16 v[108:111], v[44:47], v[64:67], v[108:111]
    s_add_u32 s82, s82, 1
    s_cmp_eq_u32 s82, 2
    s_waitcnt lgkmcnt(4)
    v_mfma_f32_16x16x32_bf16 v[112:115], v[32:35], v[68:71], v[112:115]
    ds_read_b64_tr_b16 v[80:81], v90 offset:0
    v_mfma_f32_16x16x32_bf16 v[116:119], v[36:39], v[68:71], v[116:119]
    ds_read_b64_tr_b16 v[82:83], v90 offset:768
    v_mfma_f32_16x16x32_bf16 v[120:123], v[40:43], v[68:71], v[120:123]
    s_mov_b32 s80, 53248
    s_cselect_b32 s80, 0xfffe6000, s80
    v_mfma_f32_16x16x32_bf16 v[124:127], v[44:47], v[68:71], v[124:127]
    s_cmp_eq_u32 s82, 3
    s_cselect_b32 s82, 0, s82
    s_waitcnt lgkmcnt(4)
    v_mfma_f32_16x16x32_bf16 v[128:131], v[32:35], v[72:75], v[128:131]
    ds_read_b64_tr_b16 v[64:65], v90 offset:10240
    v_mfma_f32_16x16x32_bf16 v[132:135], v[36:39], v[72:75], v[132:135]
    ds_read_b64_tr_b16 v[66:67], v90 offset:11008
    v_mfma_f32_16x16x32_bf16 v[136:139], v[40:43], v[72:75], v[136:139]
    ds_read_b128 v[48:51], v85 offset:0
    v_mfma_f32_16x16x32_bf16 v[140:143], v[44:47], v[72:75], v[140:143]
    s_waitcnt lgkmcnt(5)
    v_mfma_f32_16x16x32_bf16 v[144:147], v[32:35], v[76:79], v[144:147]
    ds_read_b64_tr_b16 v[68:69], v90 offset:32
    v_mfma_f32_16x16x32_bf16 v[148:151], v[36:39], v[76:79], v[148:151]
    ds_read_b64_tr_b16 v[70:71], v90 offset:800
    v_mfma_f32_16x16x32_bf16 v[152:155], v[40:43], v[76:79], v[152:155]
    ds_read_b128 v[52:55], v85 offset:2048
    v_mfma_f32_16x16x32_bf16 v[156:159], v[44:47], v[76:79], v[156:159]
    s_waitcnt lgkmcnt(6)
    v_mfma_f32_16x16x32_bf16 v[160:163], v[80:83], v[32:35], v[160:163]
    ds_read_b64_tr_b16 v[72:73], v90 offset:10272
    v_mfma_f32_16x16x32_bf16 v[164:167], v[80:83], v[36:39], v[164:167]
    ds_read_b64_tr_b16 v[74:75], v90 offset:11040
    v_mfma_f32_16x16x32_bf16 v[168:171], v[80:83], v[40:43], v[168:171]
    ds_read_b128 v[56:59], v85 offset:4096
    v_mfma_f32_16x16x32_bf16 v[172:175], v[80:83], v[44:47], v[172:175]
    s_waitcnt lgkmcnt(7)
    v_mfma_f32_16x16x32_bf16 v[176:179], v[64:67], v[32:35], v[176:179]
    ds_read_b64_tr_b16 v[76:77], v90 offset:64
    v_mfma_f32_16x16x32_bf16 v[180:183], v[64:67], v[36:39], v[180:183]
    ds_read_b64_tr_b16 v[78:79], v90 offset:832
    v_mfma_f32_16x16x32_bf16 v[184:187], v[64:67], v[40:43], v[184:187]
    ds_read_b128 v[60:63], v85 offset:6144
    v_mfma_f32_16x16x32_bf16 v[188:191], v[64:67], v[44:47], v[188:191]
    s_waitcnt lgkmcnt(7)
    v_mfma_f32_16x16x32_bf16 v[192:195], v[68:71], v[32:35], v[192:195]
    ds_read_b64_tr_b16 v[80:81], v90 offset:10304
    v_mfma_f32_16x16x32_bf16 v[196:199], v[68:71], v[36:39], v[196:199]
    ds_read_b64_tr_b16 v[82:83], v90 offset:11072
    v_mfma_f32_16x16x32_bf16 v[200:203], v[68:71], v[40:43], v[200:203]
    v_add_u32 v84, s80, v84
    v_mfma_f32_16x16x32_bf16 v[204:207], v[68:71], v[44:47], v[204:207]
    s_waitcnt lgkmcnt(6)
    v_mfma_f32_16x16x32_bf16 v[208:211], v[72:75], v[32:35], v[208:211]
    ds_read_b64_tr_b16 v[64:65], v86 offset:10240
    v_mfma_f32_16x16x32_bf16 v[212:215], v[72:75], v[36:39], v[212:215]
    ds_read_b64_tr_b16 v[66:67], v86 offset:10752
    v_mfma_f32_16x16x32_bf16 v[216:219], v[72:75], v[40:43], v[216:219]
    v_add_u32 v85, s80, v85
    v_mfma_f32_16x16x32_bf16 v[220:223], v[72:75], v[44:47], v[220:223]
    s_waitcnt lgkmcnt(5)
    v_mfma_f32_16x16x32_bf16 v[224:227], v[76:79], v[32:35], v[224:227]
    ds_read_b64_tr_b16 v[68:69], v87 offset:10240
    v_mfma_f32_16x16x32_bf16 v[228:231], v[76:79], v[36:39], v[228:231]
    ds_read_b64_tr_b16 v[70:71], v87 offset:10752
    v_mfma_f32_16x16x32_bf16 v[232:235], v[76:79], v[40:43], v[232:235]
    v_mfma_f32_16x16x32_bf16 v[236:239], v[76:79], v[44:47], v[236:239]
    s_waitcnt lgkmcnt(4)
    v_mfma_f32_16x16x32_bf16 v[240:243], v[80:83], v[32:35], v[240:243]
    ds_read_b64_tr_b16 v[72:73], v88 offset:10240
    v_mfma_f32_16x16x32_bf16 v[244:247], v[80:83], v[36:39], v[244:247]
    ds_read_b64_tr_b16 v[74:75], v88 offset:10752
    v_mfma_f32_16x16x32_bf16 v[248:251], v[80:83], v[40:43], v[248:251]
    v_add_u32 v86, s80, v86
    v_mfma_f32_16x16x32_bf16 v[252:255], v[80:83], v[44:47], v[252:255]
    s_waitcnt lgkmcnt(4)
    v_mfma_f32_16x16x32_bf16 v[96:99], v[48:51], v[64:67], v[96:99]
    ds_read_b64_tr_b16 v[76:77], v89 offset:10240
    v_mfma_f32_16x16x32_bf16 v[100:103], v[52:55], v[64:67], v[100:103]
    ds_read_b64_tr_b16 v[78:79], v89 offset:10752
    v_mfma_f32_16x16x32_bf16 v[104:107], v[56:59], v[64:67], v[104:107]
    v_add_u32 v87, s80, v87
    v_mfma_f32_16x16x32_bf16 v[108:111], v[60:63], v[64:67], v[108:111]
    s_waitcnt lgkmcnt(4)
    v_mfma_f32_16x16x32_bf16 v[112:115], v[48:51], v[68:71], v[112:115]
    ds_read_b64_tr_b16 v[80:81], v90 offset:5120
    v_mfma_f32_16x16x32_bf16 v[116:119], v[52:55], v[68:71], v[116:119]
    ds_read_b64_tr_b16 v[82:83], v90 offset:5888
    v_mfma_f32_16x16x32_bf16 v[120:123], v[56:59], v[68:71], v[120:123]
    v_add_u32 v88, s80, v88
    v_mfma_f32_16x16x32_bf16 v[124:127], v[60:63], v[68:71], v[124:127]
    s_waitcnt lgkmcnt(4)
    v_mfma_f32_16x16x32_bf16 v[128:131], v[48:51], v[72:75], v[128:131]
    ds_read_b64_tr_b16 v[64:65], v90 offset:15360
    v_mfma_f32_16x16x32_bf16 v[132:135], v[52:55], v[72:75], v[132:135]
    ds_read_b64_tr_b16 v[66:67], v90 offset:16128
    v_mfma_f32_16x16x32_bf16 v[136:139], v[56:59], v[72:75], v[136:139]
    v_add_u32 v89, s80, v89
    v_mfma_f32_16x16x32_bf16 v[140:143], v[60:63], v[72:75], v[140:143]
    s_waitcnt lgkmcnt(4)
    v_mfma_f32_16x16x32_bf16 v[144:147], v[48:51], v[76:79], v[144:147]
    ds_read_b64_tr_b16 v[68:69], v90 offset:5152
    v_mfma_f32_16x16x32_bf16 v[148:151], v[52:55], v[76:79], v[148:151]
    ds_read_b64_tr_b16 v[70:71], v90 offset:5920
    v_mfma_f32_16x16x32_bf16 v[152:155], v[56:59], v[76:79], v[152:155]
    v_mfma_f32_16x16x32_bf16 v[156:159], v[60:63], v[76:79], v[156:159]
    s_waitcnt lgkmcnt(4)
    v_mfma_f32_16x16x32_bf16 v[160:163], v[80:83], v[48:51], v[160:163]
    ds_read_b64_tr_b16 v[72:73], v90 offset:15392
    v_mfma_f32_16x16x32_bf16 v[164:167], v[80:83], v[52:55], v[164:167]
    ds_read_b64_tr_b16 v[74:75], v90 offset:16160
    v_mfma_f32_16x16x32_bf16 v[168:171], v[80:83], v[56:59], v[168:171]
    v_mfma_f32_16x16x32_bf16 v[172:175], v[80:83], v[60:63], v[172:175]
    s_waitcnt lgkmcnt(4)
    v_mfma_f32_16x16x32_bf16 v[176:179], v[64:67], v[48:51], v[176:179]
    ds_read_b64_tr_b16 v[76:77], v90 offset:5184
    v_mfma_f32_16x16x32_bf16 v[180:183], v[64:67], v[52:55], v[180:183]
    ds_read_b64_tr_b16 v[78:79], v90 offset:5952
    v_mfma_f32_16x16x32_bf16 v[184:187], v[64:67], v[56:59], v[184:187]
    v_mfma_f32_16x16x32_bf16 v[188:191], v[64:67], v[60:63], v[188:191]
    s_waitcnt lgkmcnt(4)
    v_mfma_f32_16x16x32_bf16 v[192:195], v[68:71], v[48:51], v[192:195]
    ds_read_b64_tr_b16 v[80:81], v90 offset:15424
    v_mfma_f32_16x16x32_bf16 v[196:199], v[68:71], v[52:55], v[196:199]
    ds_read_b64_tr_b16 v[82:83], v90 offset:16192
    v_mfma_f32_16x16x32_bf16 v[200:203], v[68:71], v[56:59], v[200:203]
    v_add_u32 v90, s80, v90
    v_mfma_f32_16x16x32_bf16 v[204:207], v[68:71], v[60:63], v[204:207]
    s_waitcnt lgkmcnt(0)
    s_barrier
    v_mfma_f32_16x16x32_bf16 v[208:211], v[72:75], v[48:51], v[208:211]
    ds_read_b64_tr_b16 v[64:65], v86 offset:0
    ds_read_b64_tr_b16 v[66:67], v86 offset:512
    v_mfma_f32_16x16x32_bf16 v[212:215], v[72:75], v[52:55], v[212:215]
    ds_read_b128 v[32:35], v84 offset:0
    v_mfma_f32_16x16x32_bf16 v[216:219], v[72:75], v[56:59], v[216:219]
    ds_read_b128 v[36:39], v84 offset:2048
    v_mfma_f32_16x16x32_bf16 v[220:223], v[72:75], v[60:63], v[220:223]
    ds_read_b128 v[40:43], v84 offset:4096
    v_mfma_f32_16x16x32_bf16 v[224:227], v[76:79], v[48:51], v[224:227]
    ds_read_b128 v[44:47], v84 offset:6144
    v_mfma_f32_16x16x32_bf16 v[228:231], v[76:79], v[52:55], v[228:231]
    ds_read_b64_tr_b16 v[68:69], v87 offset:0
    v_mfma_f32_16x16x32_bf16 v[232:235], v[76:79], v[56:59], v[232:235]
    ds_read_b64_tr_b16 v[70:71], v87 offset:512
    v_mfma_f32_16x16x32_bf16 v[236:239], v[76:79], v[60:63], v[236:239]
    v_mfma_f32_16x16x32_bf16 v[240:243], v[80:83], v[48:51], v[240:243]
    ds_read_b64_tr_b16 v[72:73], v88 offset:0
    v_mfma_f32_16x16x32_bf16 v[244:247], v[80:83], v[52:55], v[244:247]
    ds_read_b64_tr_b16 v[74:75], v88 offset:512
    v_mfma_f32_16x16x32_bf16 v[248:251], v[80:83], v[56:59], v[248:251]
    s_add_u32 s81, s81, 1
    s_cmp_lt_u32 s81, 7
    v_mfma_f32_16x16x32_bf16 v[252:255], v[80:83], v[60:63], v[252:255]
    s_cbranch_scc1 k_loop1
    s_waitcnt lgkmcnt(8)
    s_waitcnt lgkmcnt(7)
    v_mfma_f32_16x16x32_bf16 v[96:99], v[32:35], v[64:67], v[96:99]
    ds_read_b64_tr_b16 v[76:77], v86 offset:10240
    s_waitcnt lgkmcnt(7)
    v_mfma_f32_16x16x32_bf16 v[100:103], v[36:39], v[64:67], v[100:103]
    ds_read_b64_tr_b16 v[78:79], v86 offset:10752
    s_waitcnt lgkmcnt(7)
    v_mfma_f32_16x16x32_bf16 v[104:107], v[40:43], v[64:67], v[104:107]
    ds_read_b128 v[48:51], v85 offset:0
    s_waitcnt lgkmcnt(7)
    v_mfma_f32_16x16x32_bf16 v[108:111], v[44:47], v[64:67], v[108:111]
    ds_read_b128 v[52:55], v85 offset:2048
    s_waitcnt lgkmcnt(6)
    v_mfma_f32_16x16x32_bf16 v[112:115], v[32:35], v[68:71], v[112:115]
    ds_read_b64_tr_b16 v[80:81], v87 offset:10240
    v_mfma_f32_16x16x32_bf16 v[116:119], v[36:39], v[68:71], v[116:119]
    ds_read_b64_tr_b16 v[82:83], v87 offset:10752
    v_mfma_f32_16x16x32_bf16 v[120:123], v[40:43], v[68:71], v[120:123]
    ds_read_b128 v[56:59], v85 offset:4096
    v_mfma_f32_16x16x32_bf16 v[124:127], v[44:47], v[68:71], v[124:127]
    ds_read_b128 v[60:63], v85 offset:6144
    s_waitcnt lgkmcnt(8)
    v_mfma_f32_16x16x32_bf16 v[128:131], v[32:35], v[72:75], v[128:131]
    ds_read_b64_tr_b16 v[64:65], v89 offset:0
    v_mfma_f32_16x16x32_bf16 v[132:135], v[36:39], v[72:75], v[132:135]
    ds_read_b64_tr_b16 v[66:67], v89 offset:512
    v_mfma_f32_16x16x32_bf16 v[136:139], v[40:43], v[72:75], v[136:139]
    ds_read_b128 v[6:9], v93
    v_mfma_f32_16x16x32_bf16 v[140:143], v[44:47], v[72:75], v[140:143]
    s_waitcnt lgkmcnt(9)
    s_waitcnt lgkmcnt(8)
    v_mfma_f32_16x16x32_bf16 v[96:99], v[48:51], v[76:79], v[96:99]
    ds_read_b64_tr_b16 v[68:69], v88 offset:10240
    s_waitcnt lgkmcnt(8)
    v_mfma_f32_16x16x32_bf16 v[100:103], v[52:55], v[76:79], v[100:103]
    ds_read_b64_tr_b16 v[70:71], v88 offset:10752
    s_waitcnt lgkmcnt(6)
    v_mfma_f32_16x16x32_bf16 v[104:107], v[56:59], v[76:79], v[104:107]
    s_waitcnt lgkmcnt(2)
    v_lshlrev_b32 v6, 16, v6
    v_lshlrev_b32 v7, 16, v7
    v_mfma_f32_16x16x32_bf16 v[108:111], v[60:63], v[76:79], v[108:111]
    v_lshlrev_b32 v8, 16, v8
    v_lshlrev_b32 v9, 16, v9
    v_mfma_f32_16x16x32_bf16 v[112:115], v[48:51], v[80:83], v[112:115]
    ds_read_b64_tr_b16 v[72:73], v89 offset:10240
    v_mfma_f32_16x16x32_bf16 v[116:119], v[52:55], v[80:83], v[116:119]
    ds_read_b64_tr_b16 v[74:75], v89 offset:10752
    v_mfma_f32_16x16x32_bf16 v[120:123], v[56:59], v[80:83], v[120:123]
    v_fma_f32 v16, v96, s84, -s84
    v_fma_f32 v17, v97, s84, -s84
    v_fma_f32 v18, v98, s84, -s84
    v_fma_f32 v19, v99, s84, -s84
    v_fma_f32 v20, v100, s84, -s84
    v_fma_f32 v21, v101, s84, -s84
    v_mfma_f32_16x16x32_bf16 v[124:127], v[60:63], v[80:83], v[124:127]
    v_fma_f32 v22, v102, s84, -s84
    v_fma_f32 v23, v103, s84, -s84
    v_fma_f32 v24, v104, s84, -s84
    v_fma_f32 v25, v105, s84, -s84
    v_fma_f32 v26, v106, s84, -s84
    v_fma_f32 v27, v107, s84, -s84
    v_mfma_f32_16x16x32_bf16 v[144:147], v[32:35], v[64:67], v[144:147]
    ds_read_b64_tr_b16 v[76:77], v90 offset:0
    v_fma_f32 v28, v108, s84, -s84
    v_fma_f32 v29, v109, s84, -s84
    v_fma_f32 v30, v110, s84, -s84
    v_fma_f32 v31, v111, s84, -s84
    v_mfma_f32_16x16x32_bf16 v[148:151], v[36:39], v[64:67], v[148:151]
    ds_read_b64_tr_b16 v[78:79], v90 offset:768
    v_exp_f32_e64 v16, v16 clamp
    v_exp_f32_e64 v17, v17 clamp
    v_mfma_f32_16x16x32_bf16 v[152:155], v[40:43], v[64:67], v[152:155]
    v_exp_f32_e64 v18, v18 clamp
    v_exp_f32_e64 v19, v19 clamp
    v_exp_f32_e64 v20, v20 clamp
    v_mfma_f32_16x16x32_bf16 v[156:159], v[44:47], v[64:67], v[156:159]
    v_exp_f32_e64 v21, v21 clamp
    v_exp_f32_e64 v22, v22 clamp
    v_exp_f32_e64 v23, v23 clamp
    s_waitcnt lgkmcnt(4)
    v_mfma_f32_16x16x32_bf16 v[128:131], v[48:51], v[68:71], v[128:131]
    ds_read_b64_tr_b16 v[80:81], v90 offset:10240
    v_exp_f32_e64 v24, v24 clamp
    v_exp_f32_e64 v25, v25 clamp
    v_mfma_f32_16x16x32_bf16 v[132:135], v[52:55], v[68:71], v[132:135]
    ds_read_b64_tr_b16 v[82:83], v90 offset:11008
    v_exp_f32_e64 v26, v26 clamp
    v_exp_f32_e64 v27, v27 clamp
    v_mfma_f32_16x16x32_bf16 v[136:139], v[56:59], v[68:71], v[136:139]
    v_exp_f32_e64 v28, v28 clamp
    v_exp_f32_e64 v29, v29 clamp
    v_exp_f32_e64 v30, v30 clamp
    v_mfma_f32_16x16x32_bf16 v[140:143], v[60:63], v[68:71], v[140:143]
    v_exp_f32_e64 v31, v31 clamp
    v_max_f32 v16, v16, v96
    v_max_f32 v17, v17, v97
    v_max_f32 v18, v18, v98
    v_max_f32 v19, v19, v99
    s_waitcnt lgkmcnt(4)
    v_mfma_f32_16x16x32_bf16 v[144:147], v[48:51], v[72:75], v[144:147]
    ds_read_b64_tr_b16 v[64:65], v90 offset:5120
    v_max_f32 v20, v20, v100
    v_max_f32 v21, v21, v101
    v_max_f32 v22, v22, v102
    v_max_f32 v23, v23, v103
    v_max_f32 v24, v24, v104
    v_mfma_f32_16x16x32_bf16 v[148:151], v[52:55], v[72:75], v[148:151]
    ds_read_b64_tr_b16 v[66:67], v90 offset:5888
    v_max_f32 v25, v25, v105
    v_max_f32 v26, v26, v106
    v_max_f32 v27, v27, v107
    v_max_f32 v28, v28, v108
    v_max_f32 v29, v29, v109
    v_mfma_f32_16x16x32_bf16 v[152:155], v[56:59], v[72:75], v[152:155]
    v_max_f32 v30, v30, v110
    v_max_f32 v31, v31, v111
    v_add_f32 v16, s86, v16
    v_add_f32 v17, s86, v17
    v_add_f32 v18, s86, v18
    v_add_f32 v19, s86, v19
    v_mfma_f32_16x16x32_bf16 v[156:159], v[60:63], v[72:75], v[156:159]
    v_add_f32 v20, s86, v20
    v_add_f32 v21, s86, v21
    v_add_f32 v22, s86, v22
    v_add_f32 v23, s86, v23
    v_add_f32 v24, s86, v24
    v_add_f32 v25, s86, v25
    s_waitcnt lgkmcnt(4)
    v_mfma_f32_16x16x32_bf16 v[160:163], v[76:79], v[32:35], v[160:163]
    ds_read_b64_tr_b16 v[68:69], v90 offset:15360
    v_add_f32 v26, s86, v26
    v_add_f32 v27, s86, v27
    v_add_f32 v28, s86, v28
    v_add_f32 v29, s86, v29
    v_add_f32 v30, s86, v30
    v_mfma_f32_16x16x32_bf16 v[164:167], v[76:79], v[36:39], v[164:167]
    ds_read_b64_tr_b16 v[70:71], v90 offset:16128
    v_add_f32 v31, s86, v31
    v_cvt_pk_bf16_f32 v96, v16, v17
    v_cvt_pk_bf16_f32 v97, v18, v19
    v_cvt_pk_bf16_f32 v98, v20, v21
    v_cvt_pk_bf16_f32 v99, v22, v23
    v_mfma_f32_16x16x32_bf16 v[168:171], v[76:79], v[40:43], v[168:171]
    v_cvt_pk_bf16_f32 v100, v24, v25
    v_cvt_pk_bf16_f32 v101, v26, v27
    v_cvt_pk_bf16_f32 v102, v28, v29
    v_cvt_pk_bf16_f32 v103, v30, v31
    v_cvt_pk_bf16_f32 v128, v128, v129
    v_cvt_pk_bf16_f32 v129, v130, v131
    v_mfma_f32_16x16x32_bf16 v[172:175], v[76:79], v[44:47], v[172:175]
    v_cvt_pk_bf16_f32 v130, v132, v133
    v_cvt_pk_bf16_f32 v131, v134, v135
    v_cvt_pk_bf16_f32 v132, v136, v137
    v_cvt_pk_bf16_f32 v133, v138, v139
    v_cvt_pk_bf16_f32 v134, v140, v141
    v_cvt_pk_bf16_f32 v135, v142, v143
    s_waitcnt lgkmcnt(4)
    v_mfma_f32_16x16x32_bf16 v[176:179], v[80:83], v[32:35], v[176:179]
    ds_read_b64_tr_b16 v[72:73], v90 offset:32
    v_mov_b32 v136, 0x3f803f80
    v_mov_b32 v137, 0x3f803f80
    v_mov_b32 v138, 0x3f803f80
    v_mov_b32 v139, 0x3f803f80
    v_mfma_f32_16x16x32_bf16 v[180:183], v[80:83], v[36:39], v[180:183]
    ds_read_b64_tr_b16 v[74:75], v90 offset:800
    v_mfma_f32_16x16x32_bf16 v[104:107], v[96:99], v[128:131], 0
    v_mfma_f32_16x16x32_bf16 v[184:187], v[80:83], v[40:43], v[184:187]
    v_mfma_f32_16x16x32_bf16 v[108:111], v[96:99], v[136:139], 0
    v_mfma_f32_16x16x32_bf16 v[188:191], v[80:83], v[44:47], v[188:191]
    v_mfma_f32_16x16x32_bf16 v[104:107], v[100:103], v[132:135], v[104:107]
    s_waitcnt lgkmcnt(4)
    v_mfma_f32_16x16x32_bf16 v[160:163], v[64:67], v[48:51], v[160:163]
    ds_read_b64_tr_b16 v[76:77], v90 offset:10272
    v_mfma_f32_16x16x32_bf16 v[108:111], v[100:103], v[136:139], v[108:111]
    v_fma_f32 v16, v112, s84, -s84
    v_mfma_f32_16x16x32_bf16 v[164:167], v[64:67], v[52:55], v[164:167]
    ds_read_b64_tr_b16 v[78:79], v90 offset:11040
    v_fma_f32 v17, v113, s84, -s84
    v_fma_f32 v18, v114, s84, -s84
    v_fma_f32 v19, v115, s84, -s84
    v_fma_f32 v20, v116, s84, -s84
    v_fma_f32 v21, v117, s84, -s84
    v_mfma_f32_16x16x32_bf16 v[168:171], v[64:67], v[56:59], v[168:171]
    v_fma_f32 v22, v118, s84, -s84
    v_fma_f32 v23, v119, s84, -s84
    v_fma_f32 v24, v120, s84, -s84
    v_fma_f32 v25, v121, s84, -s84
    v_fma_f32 v26, v122, s84, -s84
    v_fma_f32 v27, v123, s84, -s84
    v_mfma_f32_16x16x32_bf16 v[172:175], v[64:67], v[60:63], v[172:175]
    v_fma_f32 v28, v124, s84, -s84
    v_fma_f32 v29, v125, s84, -s84
    v_fma_f32 v30, v126, s84, -s84
    v_fma_f32 v31, v127, s84, -s84
    v_exp_f32_e64 v16, v16 clamp
    s_waitcnt lgkmcnt(4)
    v_mfma_f32_16x16x32_bf16 v[176:179], v[68:71], v[48:51], v[176:179]
    ds_read_b64_tr_b16 v[80:81], v90 offset:5152
    v_exp_f32_e64 v17, v17 clamp
    v_exp_f32_e64 v18, v18 clamp
    v_mfma_f32_16x16x32_bf16 v[180:183], v[68:71], v[52:55], v[180:183]
    ds_read_b64_tr_b16 v[82:83], v90 offset:5920
    v_exp_f32_e64 v19, v19 clamp
    v_exp_f32_e64 v20, v20 clamp
    v_mfma_f32_16x16x32_bf16 v[184:187], v[68:71], v[56:59], v[184:187]
    v_exp_f32_e64 v21, v21 clamp
    v_exp_f32_e64 v22, v22 clamp
    v_exp_f32_e64 v23, v23 clamp
    v_mfma_f32_16x16x32_bf16 v[188:191], v[68:71], v[60:63], v[188:191]
    v_exp_f32_e64 v24, v24 clamp
    v_exp_f32_e64 v25, v25 clamp
    v_exp_f32_e64 v26, v26 clamp
    s_waitcnt lgkmcnt(4)
    v_mfma_f32_16x16x32_bf16 v[192:195], v[72:75], v[32:35], v[192:195]
    ds_read_b64_tr_b16 v[64:65], v90 offset:15392
    v_exp_f32_e64 v27, v27 clamp
    v_exp_f32_e64 v28, v28 clamp
    v_mfma_f32_16x16x32_bf16 v[196:199], v[72:75], v[36:39], v[196:199]
    ds_read_b64_tr_b16 v[66:67], v90 offset:16160
    v_exp_f32_e64 v29, v29 clamp
    v_exp_f32_e64 v30, v30 clamp
    v_mfma_f32_16x16x32_bf16 v[200:203], v[72:75], v[40:43], v[200:203]
    v_exp_f32_e64 v31, v31 clamp
    v_max_f32 v16, v16, v112
    v_max_f32 v17, v17, v113
    v_max_f32 v18, v18, v114
    v_max_f32 v19, v19, v115
    v_mfma_f32_16x16x32_bf16 v[204:207], v[72:75], v[44:47], v[204:207]
    v_max_f32 v20, v20, v116
    v_max_f32 v21, v21, v117
    v_max_f32 v22, v22, v118
    v_max_f32 v23, v23, v119
    v_max_f32 v24, v24, v120
    v_max_f32 v25, v25, v121
    s_waitcnt lgkmcnt(4)
    v_mfma_f32_16x16x32_bf16 v[208:211], v[76:79], v[32:35], v[208:211]
    ds_read_b64_tr_b16 v[68:69], v90 offset:64
    v_max_f32 v26, v26, v122
    v_max_f32 v27, v27, v123
    v_max_f32 v28, v28, v124
    v_max_f32 v29, v29, v125
    v_max_f32 v30, v30, v126
    v_mfma_f32_16x16x32_bf16 v[212:215], v[76:79], v[36:39], v[212:215]
    ds_read_b64_tr_b16 v[70:71], v90 offset:832
    v_max_f32 v31, v31, v127
    v_add_f32 v16, s86, v16
    v_add_f32 v17, s86, v17
    v_add_f32 v18, s86, v18
    v_add_f32 v19, s86, v19
    v_mfma_f32_16x16x32_bf16 v[216:219], v[76:79], v[40:43], v[216:219]
    v_add_f32 v20, s86, v20
    v_add_f32 v21, s86, v21
    v_add_f32 v22, s86, v22
    v_add_f32 v23, s86, v23
    v_add_f32 v24, s86, v24
    v_add_f32 v25, s86, v25
    v_mfma_f32_16x16x32_bf16 v[220:223], v[76:79], v[44:47], v[220:223]
    v_add_f32 v26, s86, v26
    v_add_f32 v27, s86, v27
    v_add_f32 v28, s86, v28
    v_add_f32 v29, s86, v29
    v_add_f32 v30, s86, v30
    v_add_f32 v31, s86, v31
    s_waitcnt lgkmcnt(4)
    v_mfma_f32_16x16x32_bf16 v[192:195], v[80:83], v[48:51], v[192:195]
    ds_read_b64_tr_b16 v[72:73], v90 offset:10304
    v_cvt_pk_bf16_f32 v112, v16, v17
    v_cvt_pk_bf16_f32 v113, v18, v19
    v_cvt_pk_bf16_f32 v114, v20, v21
    v_cvt_pk_bf16_f32 v115, v22, v23
    v_cvt_pk_bf16_f32 v116, v24, v25
    v_mfma_f32_16x16x32_bf16 v[196:199], v[80:83], v[52:55], v[196:199]
    ds_read_b64_tr_b16 v[74:75], v90 offset:11072
    v_cvt_pk_bf16_f32 v117, v26, v27
    v_cvt_pk_bf16_f32 v118, v28, v29
    v_cvt_pk_bf16_f32 v119, v30, v31
    v_cvt_pk_bf16_f32 v144, v144, v145
    v_cvt_pk_bf16_f32 v145, v146, v147
    v_mfma_f32_16x16x32_bf16 v[200:203], v[80:83], v[56:59], v[200:203]
    v_cvt_pk_bf16_f32 v146, v148, v149
    v_cvt_pk_bf16_f32 v147, v150, v151
    v_cvt_pk_bf16_f32 v148, v152, v153
    v_cvt_pk_bf16_f32 v149, v154, v155
    v_cvt_pk_bf16_f32 v150, v156, v157
    v_cvt_pk_bf16_f32 v151, v158, v159
    v_mfma_f32_16x16x32_bf16 v[204:207], v[80:83], v[60:63], v[204:207]
    v_mfma_f32_16x16x32_bf16 v[120:123], v[112:115], v[144:147], 0
    s_waitcnt lgkmcnt(4)
    v_mfma_f32_16x16x32_bf16 v[208:211], v[64:67], v[48:51], v[208:211]
    ds_read_b64_tr_b16 v[76:77], v90 offset:5184
    v_mfma_f32_16x16x32_bf16 v[124:127], v[112:115], v[136:139], 0
    v_mfma_f32_16x16x32_bf16 v[212:215], v[64:67], v[52:55], v[212:215]
    ds_read_b64_tr_b16 v[78:79], v90 offset:5952
    v_mfma_f32_16x16x32_bf16 v[120:123], v[116:119], v[148:151], v[120:123]
    v_mfma_f32_16x16x32_bf16 v[216:219], v[64:67], v[56:59], v[216:219]
    v_mfma_f32_16x16x32_bf16 v[124:127], v[116:119], v[136:139], v[124:127]
    v_mfma_f32_16x16x32_bf16 v[220:223], v[64:67], v[60:63], v[220:223]
    ds_write_b128 v92, v[104:107] offset:0
    v_mul_f32 v160, v160, v176
    s_waitcnt lgkmcnt(5)
    v_mfma_f32_16x16x32_bf16 v[224:227], v[68:71], v[32:35], v[224:227]
    ds_read_b64_tr_b16 v[80:81], v90 offset:15424
    ds_write_b128 v92, v[108:111] offset:2048
    v_mfma_f32_16x16x32_bf16 v[228:231], v[68:71], v[36:39], v[228:231]
    ds_read_b64_tr_b16 v[82:83], v90 offset:16192
    ds_write_b128 v92, v[120:123] offset:1024
    v_mfma_f32_16x16x32_bf16 v[232:235], v[68:71], v[40:43], v[232:235]
    ds_write_b128 v92, v[124:127] offset:3072
    v_mul_f32 v161, v161, v177
    v_mfma_f32_16x16x32_bf16 v[236:239], v[68:71], v[44:47], v[236:239]
    v_mul_f32 v162, v162, v178
    v_mul_f32 v163, v163, v179
    s_waitcnt lgkmcnt(8)
    v_mfma_f32_16x16x32_bf16 v[240:243], v[72:75], v[32:35], v[240:243]
    v_mul_f32 v164, v164, v180
    v_mul_f32 v165, v165, v181
    v_mfma_f32_16x16x32_bf16 v[244:247], v[72:75], v[36:39], v[244:247]
    s_waitcnt lgkmcnt(0)
    s_barrier
    v_mul_f32 v166, v166, v182
    v_mul_f32 v167, v167, v183
    v_mfma_f32_16x16x32_bf16 v[248:251], v[72:75], v[40:43], v[248:251]
    v_mul_f32 v160, v160, v6
    v_mul_f32 v161, v161, v6
    v_mfma_f32_16x16x32_bf16 v[252:255], v[72:75], v[44:47], v[252:255]
    v_mul_f32 v162, v162, v6
    v_mul_f32 v163, v163, v6
    v_mfma_f32_16x16x32_bf16 v[224:227], v[76:79], v[48:51], v[224:227]
    v_mul_f32 v164, v164, v7
    v_mul_f32 v165, v165, v7
    v_mfma_f32_16x16x32_bf16 v[228:231], v[76:79], v[52:55], v[228:231]
    v_mul_f32 v166, v166, v7
    v_mul_f32 v167, v167, v7
    v_mfma_f32_16x16x32_bf16 v[232:235], v[76:79], v[56:59], v[232:235]
    v_cvt_pk_bf16_f32 v160, v160, v161
    v_cvt_pk_bf16_f32 v161, v162, v163
    v_mfma_f32_16x16x32_bf16 v[236:239], v[76:79], v[60:63], v[236:239]
    v_cvt_pk_bf16_f32 v162, v164, v165
    v_cvt_pk_bf16_f32 v163, v166, v167
    v_mfma_f32_16x16x32_bf16 v[240:243], v[80:83], v[48:51], v[240:243]
    buffer_store_dwordx4 v[160:163], v5, s[44:47], s83 offen offset:0 sc1
    v_mul_f32 v168, v168, v184
    v_mfma_f32_16x16x32_bf16 v[244:247], v[80:83], v[52:55], v[244:247]
    v_mul_f32 v169, v169, v185
    v_mul_f32 v170, v170, v186
    v_mfma_f32_16x16x32_bf16 v[248:251], v[80:83], v[56:59], v[248:251]
    v_mul_f32 v171, v171, v187
    v_mul_f32 v172, v172, v188
    v_mfma_f32_16x16x32_bf16 v[252:255], v[80:83], v[60:63], v[252:255]
    v_mul_f32 v173, v173, v189
    v_mul_f32 v174, v174, v190
    v_mul_f32 v175, v175, v191
    v_mul_f32 v168, v168, v8
    v_mul_f32 v169, v169, v8
    v_mul_f32 v170, v170, v8
    v_mul_f32 v171, v171, v8
    v_mul_f32 v172, v172, v9
    v_mul_f32 v173, v173, v9
    v_mul_f32 v174, v174, v9
    v_mul_f32 v175, v175, v9
    v_cvt_pk_bf16_f32 v168, v168, v169
    v_cvt_pk_bf16_f32 v169, v170, v171
    v_cvt_pk_bf16_f32 v170, v172, v173
    v_cvt_pk_bf16_f32 v171, v174, v175
    buffer_store_dwordx4 v[168:171], v5, s[44:47], s83 offen offset:1024 sc1
    v_pk_mul_f32 v[192:193], v[192:193], v[208:209]
    v_pk_mul_f32 v[194:195], v[194:195], v[210:211]
    v_pk_mul_f32 v[196:197], v[196:197], v[212:213]
    v_pk_mul_f32 v[198:199], v[198:199], v[214:215]
    v_pk_mul_f32 v[192:193], v[192:193], v[6:7] op_sel_hi:[1,0]
    v_pk_mul_f32 v[194:195], v[194:195], v[6:7] op_sel_hi:[1,0]
    v_mul_f32 v196, v196, v7
    v_mul_f32 v197, v197, v7
    v_mul_f32 v198, v198, v7
    v_mul_f32 v199, v199, v7
    v_cvt_pk_bf16_f32 v192, v192, v193
    v_cvt_pk_bf16_f32 v193, v194, v195
    v_cvt_pk_bf16_f32 v194, v196, v197
    v_cvt_pk_bf16_f32 v195, v198, v199
    buffer_store_dwordx4 v[192:195], v5, s[44:47], s83 offen offset:2048 sc1
    v_pk_mul_f32 v[200:201], v[200:201], v[216:217]
    v_pk_mul_f32 v[202:203], v[202:203], v[218:219]
    v_pk_mul_f32 v[204:205], v[204:205], v[220:221]
    v_pk_mul_f32 v[206:207], v[206:207], v[222:223]
    v_pk_mul_f32 v[200:201], v[200:201], v[8:9] op_sel_hi:[1,0]
    v_pk_mul_f32 v[202:203], v[202:203], v[8:9] op_sel_hi:[1,0]
    v_mul_f32 v204, v204, v9
    v_mul_f32 v205, v205, v9
    v_mul_f32 v206, v206, v9
    v_mul_f32 v207, v207, v9
    v_cvt_pk_bf16_f32 v200, v200, v201
    v_cvt_pk_bf16_f32 v201, v202, v203
    v_cvt_pk_bf16_f32 v202, v204, v205
    v_cvt_pk_bf16_f32 v203, v206, v207
    buffer_store_dwordx4 v[200:203], v5, s[44:47], s83 offen offset:3072 sc1
    v_pk_mul_f32 v[224:225], v[224:225], v[240:241]
    v_pk_mul_f32 v[226:227], v[226:227], v[242:243]
    v_pk_mul_f32 v[228:229], v[228:229], v[244:245]
    v_pk_mul_f32 v[230:231], v[230:231], v[246:247]
    v_pk_mul_f32 v[224:225], v[224:225], v[6:7] op_sel_hi:[1,0]
    v_pk_mul_f32 v[226:227], v[226:227], v[6:7] op_sel_hi:[1,0]
    v_mul_f32 v228, v228, v7
    v_mul_f32 v229, v229, v7
    v_mul_f32 v230, v230, v7
    v_mul_f32 v231, v231, v7
    v_cvt_pk_bf16_f32 v224, v224, v225
    v_cvt_pk_bf16_f32 v225, v226, v227
    v_cvt_pk_bf16_f32 v226, v228, v229
    v_cvt_pk_bf16_f32 v227, v230, v231
    buffer_store_dwordx4 v[224:227], v5, s[44:47], s33 offen offset:0 sc1
    v_pk_mul_f32 v[232:233], v[232:233], v[248:249]
    v_pk_mul_f32 v[234:235], v[234:235], v[250:251]
    v_pk_mul_f32 v[236:237], v[236:237], v[252:253]
    v_pk_mul_f32 v[238:239], v[238:239], v[254:255]
    v_pk_mul_f32 v[232:233], v[232:233], v[8:9] op_sel_hi:[1,0]
    v_pk_mul_f32 v[234:235], v[234:235], v[8:9] op_sel_hi:[1,0]
    v_mul_f32 v236, v236, v9
    v_mul_f32 v237, v237, v9
    v_mul_f32 v238, v238, v9
    v_mul_f32 v239, v239, v9
    v_cvt_pk_bf16_f32 v232, v232, v233
    v_cvt_pk_bf16_f32 v233, v234, v235
    v_cvt_pk_bf16_f32 v234, v236, v237
    v_cvt_pk_bf16_f32 v235, v238, v239
    buffer_store_dwordx4 v[232:235], v5, s[44:47], s33 offen offset:1024 sc1
    s_setprio 3
    v_lshrrev_b32 v6, 3, v1
    s_lshl_b32 s76, s72, 7
    v_lshl_add_u32 v6, v6, 10, s76
    v_bfe_u32 v7, v1, 1, 2
    v_xor_b32 v7, v7, v3
    v_lshl_add_u32 v6, v7, 5, v6
    v_and_b32 v7, 1, v1
    v_lshl_add_u32 v84, v7, 4, v6
    v_add_u32 v85, 7168, v84
    v_add_u32 v86, 14336, v84
    v_add_u32 v87, 21504, v84
    v_lshrrev_b32 v6, 2, v1
    v_lshl_add_u32 v6, v6, 7, s92
    v_and_b32 v7, 3, v1
    v_lshl_add_u32 v6, v7, 3, v6
    v_bfe_u32 v7, v1, 3, 2
    v_lshl_add_u32 v88, v7, 5, v6
    v_xor_b32 v89, 32, v88
    v_xor_b32 v90, 64, v88
    v_xor_b32 v91, 96, v88
    s_add_u32 m0, s92, 0
    s_lshl3_add_u32 s88, s4, s89
    buffer_load_dwordx4 v84, s[56:59], s88 offen offset:0 lds
    buffer_load_dwordx4 v85, s[56:59], s88 offen offset:1024 lds
    buffer_load_dwordx4 v86, s[56:59], s88 offen offset:2048 lds
    buffer_load_dwordx4 v87, s[56:59], s88 offen offset:3072 lds
    s_add_u32 m0, s92, 4096
    s_lshl3_add_u32 s88, s5, s89
    buffer_load_dwordx4 v84, s[56:59], s88 offen offset:0 lds
    buffer_load_dwordx4 v85, s[56:59], s88 offen offset:1024 lds
    buffer_load_dwordx4 v86, s[56:59], s88 offen offset:2048 lds
    buffer_load_dwordx4 v87, s[56:59], s88 offen offset:3072 lds
    s_add_u32 m0, s92, 8192
    s_lshl3_add_u32 s88, s6, s89
    buffer_load_dwordx4 v84, s[56:59], s88 offen offset:0 lds
    buffer_load_dwordx4 v85, s[56:59], s88 offen offset:1024 lds
    buffer_load_dwordx4 v86, s[56:59], s88 offen offset:2048 lds
    buffer_load_dwordx4 v87, s[56:59], s88 offen offset:3072 lds
    s_add_u32 m0, s92, 12288
    s_lshl3_add_u32 s88, s7, s89
    buffer_load_dwordx4 v84, s[56:59], s88 offen offset:0 lds
    buffer_load_dwordx4 v85, s[56:59], s88 offen offset:1024 lds
    buffer_load_dwordx4 v86, s[56:59], s88 offen offset:2048 lds
    buffer_load_dwordx4 v87, s[56:59], s88 offen offset:3072 lds
    v_mov_b32 v0, 1
    s_waitcnt vmcnt(16)
    s_mov_b64 exec, 1
    buffer_store_dword v0, off, s[44:47], s34 sc1
    s_mov_b64 exec, -1
    s_setprio 0
    s_waitcnt vmcnt(13)
    ds_read_b64_tr_b16 v[96:97], v88 offset:0
    ds_read_b64_tr_b16 v[98:99], v88 offset:2048
    ds_read_b64_tr_b16 v[100:101], v89 offset:0
    ds_read_b64_tr_b16 v[102:103], v89 offset:2048
    ds_read_b64_tr_b16 v[104:105], v90 offset:0
    ds_read_b64_tr_b16 v[106:107], v90 offset:2048
    ds_read_b64_tr_b16 v[108:109], v91 offset:0
    ds_read_b64_tr_b16 v[110:111], v91 offset:2048
    s_waitcnt vmcnt(9)
    ds_read_b64_tr_b16 v[112:113], v88 offset:4096
    ds_read_b64_tr_b16 v[114:115], v88 offset:6144
    ds_read_b64_tr_b16 v[116:117], v89 offset:4096
    ds_read_b64_tr_b16 v[118:119], v89 offset:6144
    ds_read_b64_tr_b16 v[120:121], v90 offset:4096
    ds_read_b64_tr_b16 v[122:123], v90 offset:6144
    ds_read_b64_tr_b16 v[124:125], v91 offset:4096
    ds_read_b64_tr_b16 v[126:127], v91 offset:6144
    s_waitcnt vmcnt(5)
    ds_read_b64_tr_b16 v[128:129], v88 offset:8192
    ds_read_b64_tr_b16 v[130:131], v88 offset:10240
    ds_read_b64_tr_b16 v[132:133], v89 offset:8192
    ds_read_b64_tr_b16 v[134:135], v89 offset:10240
    ds_read_b64_tr_b16 v[136:137], v90 offset:8192
    ds_read_b64_tr_b16 v[138:139], v90 offset:10240
    ds_read_b64_tr_b16 v[140:141], v91 offset:8192
    ds_read_b64_tr_b16 v[142:143], v91 offset:10240
    buffer_load_dword v9, v2, s[44:47], s93 offen sc1
    s_waitcnt vmcnt(2)
    ds_read_b64_tr_b16 v[144:145], v88 offset:12288
    ds_read_b64_tr_b16 v[146:147], v88 offset:14336
    ds_read_b64_tr_b16 v[148:149], v89 offset:12288
    ds_read_b64_tr_b16 v[150:151], v89 offset:14336
    ds_read_b64_tr_b16 v[152:153], v90 offset:12288
    ds_read_b64_tr_b16 v[154:155], v90 offset:14336
    ds_read_b64_tr_b16 v[156:157], v91 offset:12288
    ds_read_b64_tr_b16 v[158:159], v91 offset:14336
    s_waitcnt vmcnt(0)
    v_cmp_eq_u32 s[94:95], 1, v9
    s_and_b32 s77, s94, s11
    s_cmp_eq_u32 s77, s11
    s_cbranch_scc0 k_f5
k_f5_ok:
    s_setprio 0
    s_add_u32 s91, s90, s4
    buffer_load_dwordx4 v[160:163], v5, s[44:47], s91 offen offset:0 sc1
    buffer_load_dwordx4 v[164:167], v5, s[44:47], s91 offen offset:1024 sc1
    buffer_load_dwordx4 v[168:171], v5, s[44:47], s91 offen offset:2048 sc1
    buffer_load_dwordx4 v[172:175], v5, s[44:47], s91 offen offset:3072 sc1
    s_setprio 1
    s_add_u32 s91, s90, s5
    buffer_load_dwordx4 v[176:179], v5, s[44:47], s91 offen offset:0 sc1
    buffer_load_dwordx4 v[180:183], v5, s[44:47], s91 offen offset:1024 sc1
    buffer_load_dwordx4 v[184:187], v5, s[44:47], s91 offen offset:2048 sc1
    buffer_load_dwordx4 v[188:191], v5, s[44:47], s91 offen offset:3072 sc1
    s_setprio 3
    s_add_u32 s91, s90, s6
    buffer_load_dwordx4 v[48:51], v5, s[44:47], s91 offen offset:0 sc1
    buffer_load_dwordx4 v[52:55], v5, s[44:47], s91 offen offset:1024 sc1
    buffer_load_dwordx4 v[56:59], v5, s[44:47], s91 offen offset:2048 sc1
    buffer_load_dwordx4 v[60:63], v5, s[44:47], s91 offen offset:3072 sc1
    s_lshl_b32 s76, s27, 12
    s_add_u32 s76, s76, 98304
    s_mul_i32 s92, s27, 12288
    s_waitcnt lgkmcnt(0)
    v_subrev_u32 v88, s76, v88
    v_subrev_u32 v89, s76, v89
    v_subrev_u32 v90, s76, v90
    v_subrev_u32 v91, s76, v91
    s_barrier
    buffer_load_dword v9, v2, s[44:47], s93 offen sc1
    buffer_load_dword v15, v2, s[44:47], s93 offen sc1
    buffer_load_dword v15, v2, s[44:47], s93 offen sc1
    buffer_load_dword v15, v2, s[44:47], s93 offen sc1
    buffer_load_dword v15, v2, s[44:47], s93 offen sc1
k_p2:
    s_setprio 2
    s_add_u32 s91, s90, s7
    buffer_load_dwordx4 v[64:67], v5, s[44:47], s91 offen offset:0 sc1
    buffer_load_dwordx4 v[68:71], v5, s[44:47], s91 offen offset:1024 sc1
    buffer_load_dwordx4 v[72:75], v5, s[44:47], s91 offen offset:2048 sc1
    buffer_load_dwordx4 v[76:79], v5, s[44:47], s91 offen offset:3072 sc1
    s_waitcnt vmcnt(8)
    v_cmp_eq_u32 s[94:95], 1, v9
    s_and_b32 s77, s94, s12
    s_cmp_eq_u32 s77, s12
    s_cbranch_scc0 k_f6
k_f6_ok:
    s_add_u32 s91, s90, s8
    buffer_load_dwordx4 v[16:19], v5, s[44:47], s91 offen offset:0 sc1
    buffer_load_dwordx4 v[20:23], v5, s[44:47], s91 offen offset:1024 sc1
    buffer_load_dwordx4 v[24:27], v5, s[44:47], s91 offen offset:2048 sc1
    buffer_load_dwordx4 v[28:31], v5, s[44:47], s91 offen offset:3072 sc1
    s_cmp_eq_u32 s73, 1
    s_cbranch_scc1 k_no
    s_waitcnt vmcnt(8)
    s_mov_b64 exec, 1
    buffer_store_dword v0, off, s[44:47], s35 offset:128 sc1
    s_mov_b64 exec, -1
k_no:
    v_swap_b32 v162, v168
    v_swap_b32 v163, v169
    v_swap_b32 v166, v172
    v_swap_b32 v167, v173
    v_mfma_f32_16x16x32_bf16 v[192:195], v[96:99], v[160:163], 0
    v_mfma_f32_16x16x32_bf16 v[196:199], v[96:99], v[168:171], 0
    v_mfma_f32_16x16x32_bf16 v[200:203], v[96:99], v[164:167], 0
    v_mfma_f32_16x16x32_bf16 v[204:207], v[96:99], v[172:175], 0
    v_mfma_f32_16x16x32_bf16 v[208:211], v[100:103], v[160:163], 0
    v_mfma_f32_16x16x32_bf16 v[212:215], v[100:103], v[168:171], 0
    v_mfma_f32_16x16x32_bf16 v[216:219], v[100:103], v[164:167], 0
    v_mfma_f32_16x16x32_bf16 v[220:223], v[100:103], v[172:175], 0
    v_mfma_f32_16x16x32_bf16 v[224:227], v[104:107], v[160:163], 0
    v_mfma_f32_16x16x32_bf16 v[228:231], v[104:107], v[168:171], 0
    v_mfma_f32_16x16x32_bf16 v[232:235], v[104:107], v[164:167], 0
    v_mfma_f32_16x16x32_bf16 v[236:239], v[104:107], v[172:175], 0
    v_mfma_f32_16x16x32_bf16 v[240:243], v[108:111], v[160:163], 0
    v_mfma_f32_16x16x32_bf16 v[244:247], v[108:111], v[168:171], 0
    v_mfma_f32_16x16x32_bf16 v[248:251], v[108:111], v[164:167], 0
    v_mfma_f32_16x16x32_bf16 v[252:255], v[108:111], v[172:175], 0
    s_add_u32 s91, s90, s9
    buffer_load_dwordx4 v[32:35], v5, s[44:47], s91 offen offset:0 sc1
    buffer_load_dwordx4 v[36:39], v5, s[44:47], s91 offen offset:1024 sc1
    buffer_load_dwordx4 v[40:43], v5, s[44:47], s91 offen offset:2048 sc1
    buffer_load_dwordx4 v[44:47], v5, s[44:47], s91 offen offset:3072 sc1
    s_setprio 1
    s_add_u32 s91, s90, s10
    buffer_load_dwordx4 v[160:163], v5, s[44:47], s91 offen offset:0 sc1
    buffer_load_dwordx4 v[164:167], v5, s[44:47], s91 offen offset:1024 sc1
    buffer_load_dwordx4 v[168:171], v5, s[44:47], s91 offen offset:2048 sc1
    buffer_load_dwordx4 v[172:175], v5, s[44:47], s91 offen offset:3072 sc1
    v_swap_b32 v178, v184
    v_swap_b32 v179, v185
    v_swap_b32 v182, v188
    v_swap_b32 v183, v189
    v_mfma_f32_16x16x32_bf16 v[192:195], v[112:115], v[176:179], v[192:195]
    v_mfma_f32_16x16x32_bf16 v[196:199], v[112:115], v[184:187], v[196:199]
    v_mfma_f32_16x16x32_bf16 v[200:203], v[112:115], v[180:183], v[200:203]
    v_mfma_f32_16x16x32_bf16 v[204:207], v[112:115], v[188:191], v[204:207]
    v_mfma_f32_16x16x32_bf16 v[208:211], v[116:119], v[176:179], v[208:211]
    v_mfma_f32_16x16x32_bf16 v[212:215], v[116:119], v[184:187], v[212:215]
    v_mfma_f32_16x16x32_bf16 v[216:219], v[116:119], v[180:183], v[216:219]
    v_mfma_f32_16x16x32_bf16 v[220:223], v[116:119], v[188:191], v[220:223]
    v_mfma_f32_16x16x32_bf16 v[224:227], v[120:123], v[176:179], v[224:227]
    v_mfma_f32_16x16x32_bf16 v[228:231], v[120:123], v[184:187], v[228:231]
    v_mfma_f32_16x16x32_bf16 v[232:235], v[120:123], v[180:183], v[232:235]
    v_mfma_f32_16x16x32_bf16 v[236:239], v[120:123], v[188:191], v[236:239]
    v_mfma_f32_16x16x32_bf16 v[240:243], v[124:127], v[176:179], v[240:243]
    v_mfma_f32_16x16x32_bf16 v[244:247], v[124:127], v[184:187], v[244:247]
    v_mfma_f32_16x16x32_bf16 v[248:251], v[124:127], v[180:183], v[248:251]
    v_mfma_f32_16x16x32_bf16 v[252:255], v[124:127], v[188:191], v[252:255]
    v_swap_b32 v50, v56
    v_swap_b32 v51, v57
    v_swap_b32 v54, v60
    v_swap_b32 v55, v61
    v_mfma_f32_16x16x32_bf16 v[192:195], v[128:131], v[48:51], v[192:195]
    v_mfma_f32_16x16x32_bf16 v[196:199], v[128:131], v[56:59], v[196:199]
    v_mfma_f32_16x16x32_bf16 v[200:203], v[128:131], v[52:55], v[200:203]
    v_mfma_f32_16x16x32_bf16 v[204:207], v[128:131], v[60:63], v[204:207]
    v_mfma_f32_16x16x32_bf16 v[208:211], v[132:135], v[48:51], v[208:211]
    v_mfma_f32_16x16x32_bf16 v[212:215], v[132:135], v[56:59], v[212:215]
    v_mfma_f32_16x16x32_bf16 v[216:219], v[132:135], v[52:55], v[216:219]
    v_mfma_f32_16x16x32_bf16 v[220:223], v[132:135], v[60:63], v[220:223]
    v_mfma_f32_16x16x32_bf16 v[224:227], v[136:139], v[48:51], v[224:227]
    v_mfma_f32_16x16x32_bf16 v[228:231], v[136:139], v[56:59], v[228:231]
    v_mfma_f32_16x16x32_bf16 v[232:235], v[136:139], v[52:55], v[232:235]
    v_mfma_f32_16x16x32_bf16 v[236:239], v[136:139], v[60:63], v[236:239]
    v_mfma_f32_16x16x32_bf16 v[240:243], v[140:143], v[48:51], v[240:243]
    v_mfma_f32_16x16x32_bf16 v[244:247], v[140:143], v[56:59], v[244:247]
    v_mfma_f32_16x16x32_bf16 v[248:251], v[140:143], v[52:55], v[248:251]
    v_mfma_f32_16x16x32_bf16 v[252:255], v[140:143], v[60:63], v[252:255]
    s_waitcnt vmcnt(12)
    v_swap_b32 v66, v72
    v_swap_b32 v67, v73
    v_swap_b32 v70, v76
    v_swap_b32 v71, v77
    v_mfma_f32_16x16x32_bf16 v[192:195], v[144:147], v[64:67], v[192:195]
    ds_read_b64_tr_b16 v[96:97], v88 offset:49152
    v_mfma_f32_16x16x32_bf16 v[196:199], v[144:147], v[72:75], v[196:199]
    ds_read_b64_tr_b16 v[98:99], v88 offset:51200
    v_mfma_f32_16x16x32_bf16 v[200:203], v[144:147], v[68:71], v[200:203]
    ds_read_b64_tr_b16 v[100:101], v89 offset:49152
    v_mfma_f32_16x16x32_bf16 v[204:207], v[144:147], v[76:79], v[204:207]
    ds_read_b64_tr_b16 v[102:103], v89 offset:51200
    v_mfma_f32_16x16x32_bf16 v[208:211], v[148:151], v[64:67], v[208:211]
    ds_read_b64_tr_b16 v[104:105], v90 offset:49152
    v_mfma_f32_16x16x32_bf16 v[212:215], v[148:151], v[72:75], v[212:215]
    ds_read_b64_tr_b16 v[106:107], v90 offset:51200
    v_mfma_f32_16x16x32_bf16 v[216:219], v[148:151], v[68:71], v[216:219]
    ds_read_b64_tr_b16 v[108:109], v91 offset:49152
    v_mfma_f32_16x16x32_bf16 v[220:223], v[148:151], v[76:79], v[220:223]
    ds_read_b64_tr_b16 v[110:111], v91 offset:51200
    v_mfma_f32_16x16x32_bf16 v[224:227], v[152:155], v[64:67], v[224:227]
    v_mfma_f32_16x16x32_bf16 v[228:231], v[152:155], v[72:75], v[228:231]
    v_mfma_f32_16x16x32_bf16 v[232:235], v[152:155], v[68:71], v[232:235]
    v_mfma_f32_16x16x32_bf16 v[236:239], v[152:155], v[76:79], v[236:239]
    v_mfma_f32_16x16x32_bf16 v[240:243], v[156:159], v[64:67], v[240:243]
    v_mfma_f32_16x16x32_bf16 v[244:247], v[156:159], v[72:75], v[244:247]
    v_mfma_f32_16x16x32_bf16 v[248:251], v[156:159], v[68:71], v[248:251]
    v_mfma_f32_16x16x32_bf16 v[252:255], v[156:159], v[76:79], v[252:255]
    buffer_load_dword v9, v2, s[44:47], s93 offen sc1
    s_waitcnt vmcnt(9)
    v_swap_b32 v18, v24
    v_swap_b32 v19, v25
    v_swap_b32 v22, v28
    v_swap_b32 v23, v29
    s_waitcnt lgkmcnt(0)
    v_mfma_f32_16x16x32_bf16 v[192:195], v[96:99], v[16:19], v[192:195]
    ds_read_b64_tr_b16 v[176:177], v88 offset:53248
    v_mfma_f32_16x16x32_bf16 v[196:199], v[96:99], v[24:27], v[196:199]
    ds_read_b64_tr_b16 v[178:179], v88 offset:55296
    v_mfma_f32_16x16x32_bf16 v[200:203], v[96:99], v[20:23], v[200:203]
    ds_read_b64_tr_b16 v[180:181], v89 offset:53248
    v_mfma_f32_16x16x32_bf16 v[204:207], v[96:99], v[28:31], v[204:207]
    ds_read_b64_tr_b16 v[182:183], v89 offset:55296
    v_mfma_f32_16x16x32_bf16 v[208:211], v[100:103], v[16:19], v[208:211]
    ds_read_b64_tr_b16 v[184:185], v90 offset:53248
    v_mfma_f32_16x16x32_bf16 v[212:215], v[100:103], v[24:27], v[212:215]
    ds_read_b64_tr_b16 v[186:187], v90 offset:55296
    v_mfma_f32_16x16x32_bf16 v[216:219], v[100:103], v[20:23], v[216:219]
    ds_read_b64_tr_b16 v[188:189], v91 offset:53248
    v_mfma_f32_16x16x32_bf16 v[220:223], v[100:103], v[28:31], v[220:223]
    ds_read_b64_tr_b16 v[190:191], v91 offset:55296
    v_mfma_f32_16x16x32_bf16 v[224:227], v[104:107], v[16:19], v[224:227]
    v_mfma_f32_16x16x32_bf16 v[228:231], v[104:107], v[24:27], v[228:231]
    v_mfma_f32_16x16x32_bf16 v[232:235], v[104:107], v[20:23], v[232:235]
    v_mfma_f32_16x16x32_bf16 v[236:239], v[104:107], v[28:31], v[236:239]
    v_mfma_f32_16x16x32_bf16 v[240:243], v[108:111], v[16:19], v[240:243]
    v_mfma_f32_16x16x32_bf16 v[244:247], v[108:111], v[24:27], v[244:247]
    v_mfma_f32_16x16x32_bf16 v[248:251], v[108:111], v[20:23], v[248:251]
    v_mfma_f32_16x16x32_bf16 v[252:255], v[108:111], v[28:31], v[252:255]
    s_waitcnt vmcnt(0)
    v_cmp_eq_u32 s[94:95], 1, v9
    s_and_b32 s77, s95, s13
    s_cmp_eq_u32 s77, s13
    s_cbranch_scc0 k_f7
k_f7_ok:
    s_add_u32 s91, s14, 0
    buffer_load_dwordx4 v[112:115], v5, s[44:47], s91 offen offset:0 sc1
    buffer_load_dwordx4 v[116:119], v5, s[44:47], s91 offen offset:1024 sc1
    buffer_load_dwordx4 v[120:123], v5, s[44:47], s91 offen offset:2048 sc1
    buffer_load_dwordx4 v[124:127], v5, s[44:47], s91 offen offset:3072 sc1
    s_add_u32 s91, s14, 4096
    buffer_load_dwordx4 v[48:51], v5, s[44:47], s91 offen offset:0 sc1
    buffer_load_dwordx4 v[52:55], v5, s[44:47], s91 offen offset:1024 sc1
    buffer_load_dwordx4 v[56:59], v5, s[44:47], s91 offen offset:2048 sc1
    buffer_load_dwordx4 v[60:63], v5, s[44:47], s91 offen offset:3072 sc1
    v_swap_b32 v34, v40
    v_swap_b32 v35, v41
    v_swap_b32 v38, v44
    v_swap_b32 v39, v45
    s_waitcnt lgkmcnt(0)
    v_mfma_f32_16x16x32_bf16 v[192:195], v[176:179], v[32:35], v[192:195]
    ds_read_b64_tr_b16 v[128:129], v88 offset:0
    v_mfma_f32_16x16x32_bf16 v[196:199], v[176:179], v[40:43], v[196:199]
    ds_read_b64_tr_b16 v[130:131], v88 offset:2048
    v_mfma_f32_16x16x32_bf16 v[200:203], v[176:179], v[36:39], v[200:203]
    ds_read_b64_tr_b16 v[132:133], v89 offset:0
    v_mfma_f32_16x16x32_bf16 v[204:207], v[176:179], v[44:47], v[204:207]
    ds_read_b64_tr_b16 v[134:135], v89 offset:2048
    v_mfma_f32_16x16x32_bf16 v[208:211], v[180:183], v[32:35], v[208:211]
    ds_read_b64_tr_b16 v[136:137], v90 offset:0
    v_mfma_f32_16x16x32_bf16 v[212:215], v[180:183], v[40:43], v[212:215]
    ds_read_b64_tr_b16 v[138:139], v90 offset:2048
    v_mfma_f32_16x16x32_bf16 v[216:219], v[180:183], v[36:39], v[216:219]
    ds_read_b64_tr_b16 v[140:141], v91 offset:0
    v_mfma_f32_16x16x32_bf16 v[220:223], v[180:183], v[44:47], v[220:223]
    ds_read_b64_tr_b16 v[142:143], v91 offset:2048
    v_mfma_f32_16x16x32_bf16 v[224:227], v[184:187], v[32:35], v[224:227]
    v_mfma_f32_16x16x32_bf16 v[228:231], v[184:187], v[40:43], v[228:231]
    v_mfma_f32_16x16x32_bf16 v[232:235], v[184:187], v[36:39], v[232:235]
    v_mfma_f32_16x16x32_bf16 v[236:239], v[184:187], v[44:47], v[236:239]
    v_mfma_f32_16x16x32_bf16 v[240:243], v[188:191], v[32:35], v[240:243]
    v_mfma_f32_16x16x32_bf16 v[244:247], v[188:191], v[40:43], v[244:247]
    v_mfma_f32_16x16x32_bf16 v[248:251], v[188:191], v[36:39], v[248:251]
    v_mfma_f32_16x16x32_bf16 v[252:255], v[188:191], v[44:47], v[252:255]
    v_swap_b32 v162, v168
    v_swap_b32 v163, v169
    v_swap_b32 v166, v172
    v_swap_b32 v167, v173
    s_waitcnt lgkmcnt(0)
    v_mfma_f32_16x16x32_bf16 v[192:195], v[128:131], v[160:163], v[192:195]
    ds_read_b64_tr_b16 v[64:65], v88 offset:4096
    v_mfma_f32_16x16x32_bf16 v[196:199], v[128:131], v[168:171], v[196:199]
    ds_read_b64_tr_b16 v[66:67], v88 offset:6144
    v_mfma_f32_16x16x32_bf16 v[200:203], v[128:131], v[164:167], v[200:203]
    ds_read_b64_tr_b16 v[68:69], v89 offset:4096
    v_mfma_f32_16x16x32_bf16 v[204:207], v[128:131], v[172:175], v[204:207]
    ds_read_b64_tr_b16 v[70:71], v89 offset:6144
    v_mfma_f32_16x16x32_bf16 v[208:211], v[132:135], v[160:163], v[208:211]
    ds_read_b64_tr_b16 v[72:73], v90 offset:4096
    v_mfma_f32_16x16x32_bf16 v[212:215], v[132:135], v[168:171], v[212:215]
    ds_read_b64_tr_b16 v[74:75], v90 offset:6144
    v_mfma_f32_16x16x32_bf16 v[216:219], v[132:135], v[164:167], v[216:219]
    ds_read_b64_tr_b16 v[76:77], v91 offset:4096
    v_mfma_f32_16x16x32_bf16 v[220:223], v[132:135], v[172:175], v[220:223]
    ds_read_b64_tr_b16 v[78:79], v91 offset:6144
    v_mfma_f32_16x16x32_bf16 v[224:227], v[136:139], v[160:163], v[224:227]
    v_mfma_f32_16x16x32_bf16 v[228:231], v[136:139], v[168:171], v[228:231]
    v_mfma_f32_16x16x32_bf16 v[232:235], v[136:139], v[164:167], v[232:235]
    v_mfma_f32_16x16x32_bf16 v[236:239], v[136:139], v[172:175], v[236:239]
    v_mfma_f32_16x16x32_bf16 v[240:243], v[140:143], v[160:163], v[240:243]
    v_mfma_f32_16x16x32_bf16 v[244:247], v[140:143], v[168:171], v[244:247]
    v_mfma_f32_16x16x32_bf16 v[248:251], v[140:143], v[164:167], v[248:251]
    v_mfma_f32_16x16x32_bf16 v[252:255], v[140:143], v[172:175], v[252:255]
    s_waitcnt vmcnt(4)
    v_swap_b32 v114, v120
    v_swap_b32 v115, v121
    v_swap_b32 v118, v124
    v_swap_b32 v119, v125
    s_waitcnt lgkmcnt(0)
    v_mfma_f32_16x16x32_bf16 v[192:195], v[64:67], v[112:115], v[192:195]
    ds_read_b64_tr_b16 v[144:145], v88 offset:8192
    v_mfma_f32_16x16x32_bf16 v[196:199], v[64:67], v[120:123], v[196:199]
    ds_read_b64_tr_b16 v[146:147], v88 offset:10240
    v_mfma_f32_16x16x32_bf16 v[200:203], v[64:67], v[116:119], v[200:203]
    ds_read_b64_tr_b16 v[148:149], v89 offset:8192
    v_mfma_f32_16x16x32_bf16 v[204:207], v[64:67], v[124:127], v[204:207]
    ds_read_b64_tr_b16 v[150:151], v89 offset:10240
    v_mfma_f32_16x16x32_bf16 v[208:211], v[68:71], v[112:115], v[208:211]
    ds_read_b64_tr_b16 v[152:153], v90 offset:8192
    v_mfma_f32_16x16x32_bf16 v[212:215], v[68:71], v[120:123], v[212:215]
    ds_read_b64_tr_b16 v[154:155], v90 offset:10240
    v_mfma_f32_16x16x32_bf16 v[216:219], v[68:71], v[116:119], v[216:219]
    ds_read_b64_tr_b16 v[156:157], v91 offset:8192
    v_mfma_f32_16x16x32_bf16 v[220:223], v[68:71], v[124:127], v[220:223]
    ds_read_b64_tr_b16 v[158:159], v91 offset:10240
    v_mfma_f32_16x16x32_bf16 v[224:227], v[72:75], v[112:115], v[224:227]
    v_mfma_f32_16x16x32_bf16 v[228:231], v[72:75], v[120:123], v[228:231]
    v_mfma_f32_16x16x32_bf16 v[232:235], v[72:75], v[116:119], v[232:235]
    v_mfma_f32_16x16x32_bf16 v[236:239], v[72:75], v[124:127], v[236:239]
    v_mfma_f32_16x16x32_bf16 v[240:243], v[76:79], v[112:115], v[240:243]
    v_mfma_f32_16x16x32_bf16 v[244:247], v[76:79], v[120:123], v[244:247]
    v_mfma_f32_16x16x32_bf16 v[248:251], v[76:79], v[116:119], v[248:251]
    v_mfma_f32_16x16x32_bf16 v[252:255], v[76:79], v[124:127], v[252:255]
    v_and_b32 v6, 7, v1
    v_xor_b32 v6, v6, v3
    v_lshl_add_u32 v7, v4, 8, s92
    v_lshl_add_u32 v8, v6, 4, v7
    v_xor_b32 v9, 64, v8
    s_waitcnt vmcnt(0)
    v_swap_b32 v50, v56
    v_swap_b32 v51, v57
    v_swap_b32 v54, v60
    v_swap_b32 v55, v61
    s_waitcnt lgkmcnt(0)
    v_mfma_f32_16x16x32_bf16 v[192:195], v[144:147], v[48:51], v[192:195]
    v_mfma_f32_16x16x32_bf16 v[196:199], v[144:147], v[56:59], v[196:199]
    v_mfma_f32_16x16x32_bf16 v[200:203], v[144:147], v[52:55], v[200:203]
    v_mfma_f32_16x16x32_bf16 v[204:207], v[144:147], v[60:63], v[204:207]
    s_nop 4
    ds_write_b128 v8, v[192:195] offset:0
    v_mfma_f32_16x16x32_bf16 v[208:211], v[148:151], v[48:51], v[208:211]
    ds_write_b128 v8, v[196:199] offset:4096
    v_mfma_f32_16x16x32_bf16 v[212:215], v[148:151], v[56:59], v[212:215]
    ds_write_b128 v8, v[200:203] offset:8192
    v_mfma_f32_16x16x32_bf16 v[216:219], v[148:151], v[52:55], v[216:219]
    ds_write_b128 v8, v[204:207] offset:49152
    v_mfma_f32_16x16x32_bf16 v[220:223], v[148:151], v[60:63], v[220:223]
    s_nop 1
    ds_write_b128 v9, v[208:211] offset:0
    v_mfma_f32_16x16x32_bf16 v[224:227], v[152:155], v[48:51], v[224:227]
    ds_write_b128 v9, v[212:215] offset:4096
    v_mfma_f32_16x16x32_bf16 v[228:231], v[152:155], v[56:59], v[228:231]
    ds_write_b128 v9, v[216:219] offset:8192
    v_mfma_f32_16x16x32_bf16 v[232:235], v[152:155], v[52:55], v[232:235]
    ds_write_b128 v9, v[220:223] offset:49152
    v_mfma_f32_16x16x32_bf16 v[236:239], v[152:155], v[60:63], v[236:239]
    s_nop 1
    ds_write_b128 v8, v[224:227] offset:128
    v_mfma_f32_16x16x32_bf16 v[240:243], v[156:159], v[48:51], v[240:243]
    ds_write_b128 v8, v[228:231] offset:4224
    v_mfma_f32_16x16x32_bf16 v[244:247], v[156:159], v[56:59], v[244:247]
    ds_write_b128 v8, v[232:235] offset:8320
    v_mfma_f32_16x16x32_bf16 v[248:251], v[156:159], v[52:55], v[248:251]
    ds_write_b128 v8, v[236:239] offset:49280
    v_mfma_f32_16x16x32_bf16 v[252:255], v[156:159], v[60:63], v[252:255]
    s_nop 1
    ds_write_b128 v9, v[240:243] offset:128
    s_nop 0
    ds_write_b128 v9, v[244:247] offset:4224
    s_nop 0
    ds_write_b128 v9, v[248:251] offset:8320
    s_nop 0
    ds_write_b128 v9, v[252:255] offset:49280
    s_waitcnt lgkmcnt(0)
    s_barrier
k_final:
    ds_read_b128 v[64:67], v10 offset:0
    ds_read_b128 v[68:71], v11 offset:0
    ds_read_b128 v[72:75], v10 offset:12288
    ds_read_b128 v[76:79], v11 offset:12288
    ds_read_b128 v[80:83], v10 offset:24576
    ds_read_b128 v[84:87], v11 offset:24576
    ds_read_b128 v[88:91], v10 offset:36864
    ds_read_b128 v[92:95], v11 offset:36864
    ds_read_b128 v[96:99], v12 offset:0
    ds_read_b128 v[100:103], v13 offset:0
    ds_read_b128 v[104:107], v12 offset:16384
    ds_read_b128 v[108:111], v13 offset:16384
    ds_read_b128 v[112:115], v12 offset:32768
    ds_read_b128 v[116:119], v13 offset:32768
    ds_read_b128 v[120:123], v12 offset:49152
    ds_read_b128 v[124:127], v13 offset:49152
    s_lshl_b32 s76, s71, 3
    s_add_u32 s76, s76, s70
    s_lshl_b32 s76, s76, 13
    s_lshl_b32 s77, s72, 7
    s_add_u32 s76, s76, s77
    v_lshrrev_b32 v6, 3, v1
    v_and_b32 v7, 7, v1
    v_lshlrev_b32 v7, 4, v7
    v_lshl_add_u32 v6, v6, 10, v7
    s_waitcnt lgkmcnt(12)
    v_pk_add_f32 v[64:65], v[64:65], v[72:73]
    v_pk_add_f32 v[66:67], v[66:67], v[74:75]
    v_pk_add_f32 v[68:69], v[68:69], v[76:77]
    v_pk_add_f32 v[70:71], v[70:71], v[78:79]
    s_waitcnt lgkmcnt(10)
    v_pk_add_f32 v[64:65], v[64:65], v[80:81]
    v_pk_add_f32 v[66:67], v[66:67], v[82:83]
    v_pk_add_f32 v[68:69], v[68:69], v[84:85]
    v_pk_add_f32 v[70:71], v[70:71], v[86:87]
    s_waitcnt lgkmcnt(8)
    v_pk_add_f32 v[64:65], v[64:65], v[88:89]
    v_pk_add_f32 v[66:67], v[66:67], v[90:91]
    v_pk_add_f32 v[68:69], v[68:69], v[92:93]
    v_pk_add_f32 v[70:71], v[70:71], v[94:95]
    s_waitcnt lgkmcnt(6)
    v_pk_add_f32 v[64:65], v[64:65], v[96:97]
    v_pk_add_f32 v[66:67], v[66:67], v[98:99]
    v_pk_add_f32 v[68:69], v[68:69], v[100:101]
    v_pk_add_f32 v[70:71], v[70:71], v[102:103]
    s_waitcnt lgkmcnt(4)
    v_pk_add_f32 v[64:65], v[64:65], v[104:105]
    v_pk_add_f32 v[66:67], v[66:67], v[106:107]
    v_pk_add_f32 v[68:69], v[68:69], v[108:109]
    v_pk_add_f32 v[70:71], v[70:71], v[110:111]
    s_waitcnt lgkmcnt(2)
    v_pk_add_f32 v[64:65], v[64:65], v[112:113]
    v_pk_add_f32 v[66:67], v[66:67], v[114:115]
    v_pk_add_f32 v[68:69], v[68:69], v[116:117]
    v_pk_add_f32 v[70:71], v[70:71], v[118:119]
    s_waitcnt lgkmcnt(0)
    v_pk_add_f32 v[64:65], v[64:65], v[120:121]
    v_pk_add_f32 v[66:67], v[66:67], v[122:123]
    v_pk_add_f32 v[68:69], v[68:69], v[124:125]
    v_pk_add_f32 v[70:71], v[70:71], v[126:127]
    v_cvt_pk_bf16_f32 v16, v64, v65
    v_cvt_pk_bf16_f32 v17, v66, v67
    v_cvt_pk_bf16_f32 v18, v68, v69
    v_cvt_pk_bf16_f32 v19, v70, v71
    buffer_store_dwordx4 v[16:19], v6, s[60:63], s76 offen sc1
k_end:
    s_endpgm
k_init:
    s_mov_b32 s26, 0x8000
k_init_l:
    s_sleep 4
    buffer_load_dword v47, v17, s[64:67], 0 offen sc1
    s_waitcnt vmcnt(0)
    v_cmp_eq_u32 vcc, 0, v47
    s_cmp_eq_u64 vcc, 0
    s_cbranch_scc1 k_init_ok
    s_sub_u32 s26, s26, 1
    s_cbranch_scc0 k_init_l
    s_branch k_init_ok
k_gs:
    s_mov_b32 s26, 0x8000
k_gs_l:
    s_sleep 4
    buffer_load_dword v47, v16, s[44:47], s20 offen sc1
    s_waitcnt vmcnt(0)
    v_cmp_eq_u32 vcc, -1, v47
    s_cmp_eq_u64 vcc, 0
    s_cbranch_scc1 k_gs_ok
    s_sub_u32 s26, s26, 1
    s_cbranch_scc0 k_gs_l
    s_branch k_gs_ok
k_ks:
    s_mov_b32 s26, 0x8000
k_ks_l:
    s_sleep 2
    buffer_load_dwordx2 v[192:193], v6, s[44:47], s18 offen offset:0 sc1
    buffer_load_dwordx2 v[194:195], v6, s[44:47], s18 offen offset:512 sc1
    buffer_load_dwordx2 v[196:197], v6, s[44:47], s18 offen offset:1024 sc1
    buffer_load_dwordx2 v[198:199], v6, s[44:47], s18 offen offset:1536 sc1
    buffer_load_dwordx2 v[200:201], v6, s[44:47], s18 offen offset:2048 sc1
    buffer_load_dwordx2 v[202:203], v6, s[44:47], s18 offen offset:2560 sc1
    buffer_load_dwordx2 v[204:205], v6, s[44:47], s18 offen offset:3072 sc1
    buffer_load_dwordx2 v[206:207], v6, s[44:47], s18 offen offset:3584 sc1
    buffer_load_dword v208, v8, s[44:47], s19 offen sc1
    s_waitcnt vmcnt(0)
    v_max3_u32 v212, v192, v193, v194
    v_max3_u32 v213, v196, v197, v198
    v_max3_u32 v214, v200, v201, v202
    v_max3_u32 v215, v204, v205, v206
    v_max3_u32 v212, v212, v195, v199
    v_max3_u32 v213, v213, v203, v207
    v_max3_u32 v214, v214, v215, v208
    v_max3_u32 v212, v212, v213, v214
    v_cmp_eq_u32 vcc, -1, v212
    s_cmp_eq_u64 vcc, 0
    s_cbranch_scc1 k_ks_ok
    s_sub_u32 s26, s26, 1
    s_cbranch_scc0 k_ks_l
    s_branch k_ks_ok
k_f1:
    s_mov_b32 s26, 0x8000
k_f1_l:
    s_sleep 2
    buffer_load_dword v9, v2, s[44:47], s93 offen sc1
    s_waitcnt vmcnt(0)
    v_cmp_eq_u32 s[94:95], 1, v9
    s_and_b32 s77, s94, s11
    s_cmp_eq_u32 s77, s11
    s_cbranch_scc1 k_f1_ok
    s_sub_u32 s26, s26, 1
    s_cbranch_scc0 k_f1_l
    s_branch k_f1_ok
k_f2:
    s_mov_b32 s26, 0x8000
k_f2_l:
    s_sleep 2
    buffer_load_dword v9, v2, s[44:47], s93 offen sc1
    s_waitcnt vmcnt(0)
    v_cmp_eq_u32 s[94:95], 1, v9
    s_and_b32 s77, s94, s12
    s_cmp_eq_u32 s77, s12
    s_cbranch_scc1 k_f2_ok
    s_sub_u32 s26, s26, 1
    s_cbranch_scc0 k_f2_l
    s_branch k_f2_ok
k_f3:
    s_mov_b32 s26, 0x8000
k_f3_l:
    s_sleep 2
    buffer_load_dword v9, v2, s[44:47], s93 offen sc1
    s_waitcnt vmcnt(0)
    v_cmp_eq_u32 s[94:95], 1, v9
    s_and_b32 s77, s95, s13
    s_cmp_eq_u32 s77, s13
    s_cbranch_scc1 k_f3_ok
    s_sub_u32 s26, s26, 1
    s_cbranch_scc0 k_f3_l
    s_branch k_f3_ok
k_f4:
    s_mov_b32 s26, 0x8000
k_f4_l:
    s_sleep 2
    buffer_load_dword v9, v2, s[44:47], s93 offen sc1
    s_waitcnt vmcnt(0)
    v_cmp_eq_u32 s[94:95], 1, v9
    s_and_b32 s77, s94, s11
    s_cmp_eq_u32 s77, s11
    s_cbranch_scc1 k_f4_ok
    s_sub_u32 s26, s26, 1
    s_cbranch_scc0 k_f4_l
    s_branch k_f4_ok
k_f5:
    s_mov_b32 s26, 0x8000
k_f5_l:
    s_sleep 2
    buffer_load_dword v9, v2, s[44:47], s93 offen sc1
    s_waitcnt vmcnt(0)
    v_cmp_eq_u32 s[94:95], 1, v9
    s_and_b32 s77, s94, s11
    s_cmp_eq_u32 s77, s11
    s_cbranch_scc1 k_f5_ok
    s_sub_u32 s26, s26, 1
    s_cbranch_scc0 k_f5_l
    s_branch k_f5_ok
k_f6:
    s_mov_b32 s26, 0x8000
    s_cmp_eq_u32 s73, 1
    s_cbranch_scc1 k_f6_n
    s_waitcnt vmcnt(0)
    s_mov_b64 exec, 1
    buffer_store_dword v0, off, s[44:47], s35 offset:128 sc1
    s_mov_b64 exec, -1
k_f6_n:
k_f6_l:
    s_sleep 2
    buffer_load_dword v9, v2, s[44:47], s93 offen sc1
    s_waitcnt vmcnt(0)
    v_cmp_eq_u32 s[94:95], 1, v9
    s_and_b32 s77, s94, s12
    s_cmp_eq_u32 s77, s12
    s_cbranch_scc1 k_f6_ok
    s_sub_u32 s26, s26, 1
    s_cbranch_scc0 k_f6_l
    s_branch k_f6_ok
k_f7:
    s_mov_b32 s26, 0x8000
k_f7_l:
    s_sleep 2
    buffer_load_dword v9, v2, s[44:47], s93 offen sc1
    s_waitcnt vmcnt(0)
    v_cmp_eq_u32 s[94:95], 1, v9
    s_and_b32 s77, s95, s13
    s_cmp_eq_u32 s77, s13
    s_cbranch_scc1 k_f7_ok
    s_sub_u32 s26, s26, 1
    s_cbranch_scc0 k_f7_l
    s_branch k_f7_ok
k_last:
    s_endpgm
.section .rodata,"a"
.p2align 6
.amdhsa_kernel gated_mix__linear_attn_block__glu_gated_bilinear__prompt_kernel
  .amdhsa_next_free_vgpr 256
  .amdhsa_next_free_sgpr 100
  .amdhsa_accum_offset 256
  .amdhsa_group_segment_fixed_size 0
  .amdhsa_kernarg_size 88
  .amdhsa_user_sgpr_count 2
  .amdhsa_user_sgpr_kernarg_segment_ptr 1
  .amdhsa_system_sgpr_workgroup_id_x 1
.end_amdhsa_kernel
```
